```python
import torch

def _softmax(x, axis=-1):
    return torch.softmax(x, dim=axis)
def _gelu(x):
    return torch.nn.functional.gelu(x, approximate="tanh")
def _silu(x):
    return torch.nn.functional.silu(x)
def _sigmoid(x):
    return torch.sigmoid(x)
def _layernorm(x, axis=-1, eps=1e-5):
    m = x.mean(dim=axis, keepdim=True)
    v = x.var(dim=axis, keepdim=True, unbiased=False)
    return (x - m) / torch.sqrt(v + eps)
def _scatter_add(tgt, idx, src, axis=0):
    return tgt.clone().index_add_(axis, idx, src)
def _segment_sum(src, seg, n):
    out = torch.zeros((n,) + src.shape[1:], dtype=src.dtype)
    return out.index_add_(0, seg, src)
def _pad(x, pw):
    flat = tuple(v for pair in reversed(pw) for v in pair)
    return torch.nn.functional.pad(x, flat)

kernel_name = 'standalone__gqa_softmax__near_ridge'

def setup_inputs():

    _w = (lambda a: (lambda t: t.to(torch.bfloat16) if t.is_floating_point() else t)(torch.as_tensor(a)))
    B, Hq, Hkv, Sq, Sk, D = 8, 32, 8, 320, 320, 128
    return {
        "q": _w((lambda *s: torch.randn(*s, dtype=torch.bfloat16) * 0.8)(B, Hq, Sq, D)),
        "k": _w((lambda *s: torch.randn(*s, dtype=torch.bfloat16) * 0.8)(B, Hkv, Sk, D)),
        "v": _w((lambda *s: torch.randn(*s, dtype=torch.bfloat16) * 0.05)(B, Hkv, Sk, D)),
    }

def reference(q, k, v):
    B, Hq, Sq, D = q.shape
    Hkv = k.shape[1]
    rep = Hq // Hkv
    k = (lambda x, n, axis: torch.repeat_interleave(x, n, dim=axis))(k, rep, axis=1)
    v = (lambda x, n, axis: torch.repeat_interleave(x, n, dim=axis))(v, rep, axis=1)
    scale = D ** -0.5
    scores = torch.einsum("bhqd,bhkd->bhqk", q, k) * scale
    p = _softmax(scores, axis=-1)
    return torch.einsum("bhqk,bhkd->bhqd", p, v)
```

```asm
; @launch grid=(256,1,1) block=(512,1,1) lds=163840
.amdgcn_target "amdgcn-amd-amdhsa--gfx950"
.text
.globl standalone__gqa_softmax__near_ridge_kernel
.p2align 8
.type standalone__gqa_softmax__near_ridge_kernel,@function
standalone__gqa_softmax__near_ridge_kernel:
    s_cmp_ge_u32 s2, 256
    s_cbranch_scc1 L_end
    s_load_dwordx4 s[4:7], s[0:1], 0
    s_load_dwordx4 s[8:11], s[0:1], 16
    s_getpc_b64 s[46:47]
L_pc:
    v_lshlrev_b32 v252, 7, v0
    v_subrev_u32 v252, 0x8000, v252
    v_min_u32 v252, L_end-L_pc, v252
    global_load_dword v159, v252, s[46:47]
    s_and_b32 s12, s2, 7
    s_lshr_b32 s13, s2, 3
    s_lshr_b32 s14, s13, 2
    s_lshl_b32 s14, s14, 3
    s_add_u32 s14, s14, s12
    s_and_b32 s13, s13, 3
    s_lshl_b32 s15, s14, 2
    s_add_u32 s15, s15, s13
    s_mul_i32 s16, s14, 81920
    s_mul_i32 s17, s15, 81920
    v_lshrrev_b32 v252, 6, v0
    v_and_b32 v251, 63, v0
    v_readfirstlane_b32 s18, v252
    v_lshrrev_b32 v0, 4, v251
    v_and_b32 v1, 15, v251
    v_xor_b32 v2, v0, v1
    v_lshlrev_b32 v2, 4, v2
    v_lshl_or_b32 v10, v0, 8, v2
    v_xor_b32 v11, 64, v10
    v_xor_b32 v12, 128, v10
    v_xor_b32 v13, 192, v10
    s_and_b32 s36, s18, 3
    s_lshr_b32 s37, s18, 2
    s_mul_i32 s38, s36, 80
    s_lshl_b32 s39, s37, 5
    s_add_u32 s38, s38, s39
    s_lshl_b32 s40, s18, 10
    s_and_b32 s42, s18, 1
    s_lshl_b32 s43, s42, 7
    s_mul_i32 s48, s13, 5
    s_add_u32 s48, s48, 1
    s_lshr_b32 s48, s48, 1
    s_mul_i32 s48, s48, 0
    s_lshl_b32 s45, s38, 8
    s_mov_b32 s52, 0x3e0293ee
    s_mov_b32 s53, 0x3e0293ee
    v_and_b32 v2, 31, v251
    v_lshrrev_b32 v3, 5, v251
    v_add_u32 v4, s38, v2
    v_lshlrev_b32 v5, 4, v3
    v_lshl_or_b32 v250, v4, 8, v5
    s_waitcnt lgkmcnt(0)
    s_add_u32 s20, s4, s17
    s_addc_u32 s21, s5, 0
    s_mov_b32 s22, 81920
    s_mov_b32 s23, 0x00020000
    s_add_u32 s24, s6, s16
    s_addc_u32 s25, s7, 0
    s_mov_b32 s26, 81920
    s_mov_b32 s27, 0x00020000
    s_add_u32 s28, s8, s16
    s_addc_u32 s29, s9, 0
    s_mov_b32 s30, 81920
    s_mov_b32 s31, 0x00020000
    s_add_u32 s32, s10, s17
    s_addc_u32 s33, s11, 0
    s_mov_b32 s34, 81920
    s_mov_b32 s35, 0x00020000
    s_lshl_b32 s39, s36, 11
    v_xor_b32 v232, s43, v10
    v_xor_b32 v233, 64, v232
    s_cmp_ge_u32 s18, 4
    s_cbranch_scc1 L_noqdma
    s_add_u32 m0, s40, 81920
    s_add_u32 s41, s45, 0
    buffer_load_dwordx4 v10, s[20:23], s41 offen lds
    s_add_u32 m0, s40, 90112
    s_add_u32 s41, s45, 1024
    buffer_load_dwordx4 v11, s[20:23], s41 offen lds
    s_add_u32 m0, s40, 98304
    s_add_u32 s41, s45, 2048
    buffer_load_dwordx4 v12, s[20:23], s41 offen lds
    s_add_u32 m0, s40, 106496
    s_add_u32 s41, s45, 3072
    buffer_load_dwordx4 v13, s[20:23], s41 offen lds
    s_add_u32 m0, s40, 114688
    s_add_u32 s41, s45, 4096
    buffer_load_dwordx4 v10, s[20:23], s41 offen lds
    s_add_u32 m0, s40, 122880
    s_add_u32 s41, s45, 5120
    buffer_load_dwordx4 v11, s[20:23], s41 offen lds
    s_add_u32 m0, s40, 131072
    s_add_u32 s41, s45, 6144
    buffer_load_dwordx4 v12, s[20:23], s41 offen lds
    s_add_u32 m0, s40, 139264
    s_add_u32 s41, s45, 7168
    buffer_load_dwordx4 v13, s[20:23], s41 offen lds
    s_branch L_nokdma
L_noqdma:
    s_add_u32 m0, s39, 0
    s_add_u32 s41, s48, 0
    s_cmp_ge_u32 s41, 81920
    s_cselect_b32 s49, 81920, 0
    s_sub_u32 s41, s41, s49
    s_add_u32 s41, s41, s39
    buffer_load_dwordx4 v232, s[24:27], s41 offen lds
    s_add_u32 m0, s39, 1024
    s_add_u32 s41, s41, 1024
    buffer_load_dwordx4 v233, s[24:27], s41 offen lds
    s_add_u32 m0, s39, 8192
    s_add_u32 s41, s48, 8192
    s_cmp_ge_u32 s41, 81920
    s_cselect_b32 s49, 81920, 0
    s_sub_u32 s41, s41, s49
    s_add_u32 s41, s41, s39
    buffer_load_dwordx4 v232, s[24:27], s41 offen lds
    s_add_u32 m0, s39, 9216
    s_add_u32 s41, s41, 1024
    buffer_load_dwordx4 v233, s[24:27], s41 offen lds
    s_add_u32 m0, s39, 16384
    s_add_u32 s41, s48, 16384
    s_cmp_ge_u32 s41, 81920
    s_cselect_b32 s49, 81920, 0
    s_sub_u32 s41, s41, s49
    s_add_u32 s41, s41, s39
    buffer_load_dwordx4 v232, s[24:27], s41 offen lds
    s_add_u32 m0, s39, 17408
    s_add_u32 s41, s41, 1024
    buffer_load_dwordx4 v233, s[24:27], s41 offen lds
    s_add_u32 m0, s39, 24576
    s_add_u32 s41, s48, 24576
    s_cmp_ge_u32 s41, 81920
    s_cselect_b32 s49, 81920, 0
    s_sub_u32 s41, s41, s49
    s_add_u32 s41, s41, s39
    buffer_load_dwordx4 v232, s[24:27], s41 offen lds
    s_add_u32 m0, s39, 25600
    s_add_u32 s41, s41, 1024
    buffer_load_dwordx4 v233, s[24:27], s41 offen lds
    s_add_u32 m0, s39, 32768
    s_add_u32 s41, s48, 32768
    s_cmp_ge_u32 s41, 81920
    s_cselect_b32 s49, 81920, 0
    s_sub_u32 s41, s41, s49
    s_add_u32 s41, s41, s39
    buffer_load_dwordx4 v232, s[24:27], s41 offen lds
    s_add_u32 m0, s39, 33792
    s_add_u32 s41, s41, 1024
    buffer_load_dwordx4 v233, s[24:27], s41 offen lds
L_nokdma:
    v_lshlrev_b32 v3, 1, v0
    v_lshlrev_b32 v3, 1, v3
    v_xor_b32 v3, v3, v1
    v_lshlrev_b32 v3, 4, v3
    v_lshl_or_b32 v9, v0, 8, v3
    v_and_b32 v2, 31, v251
    v_lshrrev_b32 v3, 5, v251
    v_xor_b32 v4, v1, v3
    v_lshlrev_b32 v4, 4, v4
    v_lshl_or_b32 v224, v2, 8, v4
    v_xor_b32 v225, 32, v224
    v_xor_b32 v226, 64, v224
    v_xor_b32 v227, 96, v224
    v_xor_b32 v228, 128, v224
    v_xor_b32 v229, 160, v224
    v_xor_b32 v230, 192, v224
    v_xor_b32 v231, 224, v224
    v_lshrrev_b32 v5, 2, v2
    v_lshl_or_b32 v4, v5, 13, v4
    v_and_b32 v5, 3, v2
    v_lshl_or_b32 v4, v5, 8, v4
    s_add_u32 s41, s40, 81920
    v_add_u32 v16, s41, v4
    v_xor_b32 v17, 32, v16
    v_xor_b32 v18, 64, v16
    v_xor_b32 v19, 96, v16
    v_xor_b32 v20, 128, v16
    v_xor_b32 v21, 160, v16
    v_xor_b32 v22, 192, v16
    v_xor_b32 v23, 224, v16
    v_bfe_u32 v2, v251, 2, 2
    v_lshl_or_b32 v4, v2, 1, v3
    v_bfe_u32 v5, v251, 4, 1
    v_xor_b32 v4, v4, v5
    v_lshlrev_b32 v4, 5, v4
    v_lshl_add_u32 v5, v3, 2, v2
    v_lshl_or_b32 v4, v5, 8, v4
    v_and_b32 v5, 1, v251
    v_lshl_or_b32 v4, v5, 4, v4
    v_bfe_u32 v5, v251, 1, 1
    v_lshl_or_b32 v4, v5, 3, v4
    v_add_u32 v244, 81920, v4
    v_xor_b32 v245, 64, v244
    v_xor_b32 v246, 128, v244
    v_xor_b32 v247, 192, v244
    v_mov_b32 v248, 0xff800000
    v_mov_b32 v249, 0
    v_mov_b32 v255, 0
    v_mov_b32 v254, v9
    v_xor_b32 v253, 32, v9
    s_cmp_ge_u32 s18, 4
    s_cbranch_scc1 L_bpre
    s_waitcnt vmcnt(0)
    ds_read_b128 v[160:163], v16 offset:0
    ds_read_b128 v[164:167], v17 offset:0
    ds_read_b128 v[168:171], v18 offset:0
    ds_read_b128 v[172:175], v19 offset:0
    ds_read_b128 v[176:179], v20 offset:0
    ds_read_b128 v[180:183], v21 offset:0
    ds_read_b128 v[184:187], v22 offset:0
    ds_read_b128 v[188:191], v23 offset:0
    s_waitcnt lgkmcnt(0)
    s_barrier
    ds_read_b128 v[192:195], v224 offset:0
    ds_read_b128 v[196:199], v225 offset:0
    ds_read_b128 v[200:203], v226 offset:0
    ds_read_b128 v[204:207], v227 offset:0
    ds_read_b128 v[208:211], v228 offset:0
    ds_read_b128 v[212:215], v229 offset:0
    ds_read_b128 v[216:219], v230 offset:0
    ds_read_b128 v[220:223], v231 offset:0
    s_barrier
    s_waitcnt lgkmcnt(7)
    v_mfma_f32_32x32x16_bf16 v[0:15], v[192:195], v[160:163], 0
    ds_read_b128 v[192:195], v224 offset:8192
    s_waitcnt lgkmcnt(7)
    v_mfma_f32_32x32x16_bf16 v[0:15], v[196:199], v[164:167], v[0:15]
    ds_read_b128 v[196:199], v225 offset:8192
    s_waitcnt lgkmcnt(7)
    v_mfma_f32_32x32x16_bf16 v[0:15], v[200:203], v[168:171], v[0:15]
    ds_read_b128 v[200:203], v226 offset:8192
    s_waitcnt lgkmcnt(7)
    v_mfma_f32_32x32x16_bf16 v[0:15], v[204:207], v[172:175], v[0:15]
    ds_read_b128 v[204:207], v227 offset:8192
    s_waitcnt lgkmcnt(7)
    v_mfma_f32_32x32x16_bf16 v[0:15], v[208:211], v[176:179], v[0:15]
    ds_read_b128 v[208:211], v228 offset:8192
    s_waitcnt lgkmcnt(7)
    v_mfma_f32_32x32x16_bf16 v[0:15], v[212:215], v[180:183], v[0:15]
    ds_read_b128 v[212:215], v229 offset:8192
    s_waitcnt lgkmcnt(7)
    v_mfma_f32_32x32x16_bf16 v[0:15], v[216:219], v[184:187], v[0:15]
    ds_read_b128 v[216:219], v230 offset:8192
    s_waitcnt lgkmcnt(7)
    v_mfma_f32_32x32x16_bf16 v[0:15], v[220:223], v[188:191], v[0:15]
    ds_read_b128 v[220:223], v231 offset:8192
    s_barrier
    s_waitcnt lgkmcnt(7)
    v_mfma_f32_32x32x16_bf16 v[16:31], v[192:195], v[160:163], 0
    ds_read_b128 v[192:195], v224 offset:16384
    s_waitcnt lgkmcnt(7)
    v_mfma_f32_32x32x16_bf16 v[16:31], v[196:199], v[164:167], v[16:31]
    ds_read_b128 v[196:199], v225 offset:16384
    s_waitcnt lgkmcnt(7)
    v_mfma_f32_32x32x16_bf16 v[16:31], v[200:203], v[168:171], v[16:31]
    ds_read_b128 v[200:203], v226 offset:16384
    s_waitcnt lgkmcnt(7)
    v_mfma_f32_32x32x16_bf16 v[16:31], v[204:207], v[172:175], v[16:31]
    ds_read_b128 v[204:207], v227 offset:16384
    s_waitcnt lgkmcnt(7)
    v_mfma_f32_32x32x16_bf16 v[16:31], v[208:211], v[176:179], v[16:31]
    ds_read_b128 v[208:211], v228 offset:16384
    v_max3_f32 v248, v248, v0, v1
    v_max3_f32 v248, v248, v2, v3
    s_waitcnt lgkmcnt(7)
    v_mfma_f32_32x32x16_bf16 v[16:31], v[212:215], v[180:183], v[16:31]
    ds_read_b128 v[212:215], v229 offset:16384
    v_max3_f32 v248, v248, v4, v5
    v_max3_f32 v248, v248, v6, v7
    s_waitcnt lgkmcnt(7)
    v_mfma_f32_32x32x16_bf16 v[16:31], v[216:219], v[184:187], v[16:31]
    ds_read_b128 v[216:219], v230 offset:16384
    v_max3_f32 v248, v248, v8, v9
    v_max3_f32 v248, v248, v10, v11
    s_waitcnt lgkmcnt(7)
    v_mfma_f32_32x32x16_bf16 v[16:31], v[220:223], v[188:191], v[16:31]
    ds_read_b128 v[220:223], v231 offset:16384
    v_max3_f32 v248, v248, v12, v13
    v_max3_f32 v248, v248, v14, v15
    s_barrier
    s_waitcnt lgkmcnt(7)
    v_mfma_f32_32x32x16_bf16 v[32:47], v[192:195], v[160:163], 0
    ds_read_b128 v[192:195], v224 offset:24576
    s_waitcnt lgkmcnt(7)
    v_mfma_f32_32x32x16_bf16 v[32:47], v[196:199], v[164:167], v[32:47]
    ds_read_b128 v[196:199], v225 offset:24576
    s_waitcnt lgkmcnt(7)
    v_mfma_f32_32x32x16_bf16 v[32:47], v[200:203], v[168:171], v[32:47]
    ds_read_b128 v[200:203], v226 offset:24576
    s_waitcnt lgkmcnt(7)
    v_mfma_f32_32x32x16_bf16 v[32:47], v[204:207], v[172:175], v[32:47]
    ds_read_b128 v[204:207], v227 offset:24576
    s_waitcnt lgkmcnt(7)
    v_mfma_f32_32x32x16_bf16 v[32:47], v[208:211], v[176:179], v[32:47]
    ds_read_b128 v[208:211], v228 offset:24576
    v_max3_f32 v248, v248, v16, v17
    v_max3_f32 v248, v248, v18, v19
    s_waitcnt lgkmcnt(7)
    v_mfma_f32_32x32x16_bf16 v[32:47], v[212:215], v[180:183], v[32:47]
    ds_read_b128 v[212:215], v229 offset:24576
    v_max3_f32 v248, v248, v20, v21
    v_max3_f32 v248, v248, v22, v23
    s_waitcnt lgkmcnt(7)
    v_mfma_f32_32x32x16_bf16 v[32:47], v[216:219], v[184:187], v[32:47]
    ds_read_b128 v[216:219], v230 offset:24576
    v_max3_f32 v248, v248, v24, v25
    v_max3_f32 v248, v248, v26, v27
    s_waitcnt lgkmcnt(7)
    v_mfma_f32_32x32x16_bf16 v[32:47], v[220:223], v[188:191], v[32:47]
    ds_read_b128 v[220:223], v231 offset:24576
    v_max3_f32 v248, v248, v28, v29
    v_max3_f32 v248, v248, v30, v31
    s_barrier
    s_waitcnt lgkmcnt(7)
    v_mfma_f32_32x32x16_bf16 v[48:63], v[192:195], v[160:163], 0
    ds_read_b128 v[192:195], v224 offset:32768
    s_waitcnt lgkmcnt(7)
    v_mfma_f32_32x32x16_bf16 v[48:63], v[196:199], v[164:167], v[48:63]
    ds_read_b128 v[196:199], v225 offset:32768
    s_waitcnt lgkmcnt(7)
    v_mfma_f32_32x32x16_bf16 v[48:63], v[200:203], v[168:171], v[48:63]
    ds_read_b128 v[200:203], v226 offset:32768
    s_waitcnt lgkmcnt(7)
    v_mfma_f32_32x32x16_bf16 v[48:63], v[204:207], v[172:175], v[48:63]
    ds_read_b128 v[204:207], v227 offset:32768
    s_waitcnt lgkmcnt(7)
    v_mfma_f32_32x32x16_bf16 v[48:63], v[208:211], v[176:179], v[48:63]
    ds_read_b128 v[208:211], v228 offset:32768
    v_max3_f32 v248, v248, v32, v33
    v_max3_f32 v248, v248, v34, v35
    s_waitcnt lgkmcnt(7)
    v_mfma_f32_32x32x16_bf16 v[48:63], v[212:215], v[180:183], v[48:63]
    ds_read_b128 v[212:215], v229 offset:32768
    v_max3_f32 v248, v248, v36, v37
    v_max3_f32 v248, v248, v38, v39
    s_waitcnt lgkmcnt(7)
    v_mfma_f32_32x32x16_bf16 v[48:63], v[216:219], v[184:187], v[48:63]
    ds_read_b128 v[216:219], v230 offset:32768
    v_max3_f32 v248, v248, v40, v41
    v_max3_f32 v248, v248, v42, v43
    s_waitcnt lgkmcnt(7)
    v_mfma_f32_32x32x16_bf16 v[48:63], v[220:223], v[188:191], v[48:63]
    ds_read_b128 v[220:223], v231 offset:32768
    v_max3_f32 v248, v248, v44, v45
    v_max3_f32 v248, v248, v46, v47
    s_barrier
    s_waitcnt lgkmcnt(7)
    v_mfma_f32_32x32x16_bf16 v[64:79], v[192:195], v[160:163], 0
    ds_read_b128 v[192:195], v224 offset:40960
    s_waitcnt lgkmcnt(7)
    v_mfma_f32_32x32x16_bf16 v[64:79], v[196:199], v[164:167], v[64:79]
    ds_read_b128 v[196:199], v225 offset:40960
    s_waitcnt lgkmcnt(7)
    v_mfma_f32_32x32x16_bf16 v[64:79], v[200:203], v[168:171], v[64:79]
    ds_read_b128 v[200:203], v226 offset:40960
    s_waitcnt lgkmcnt(7)
    v_mfma_f32_32x32x16_bf16 v[64:79], v[204:207], v[172:175], v[64:79]
    ds_read_b128 v[204:207], v227 offset:40960
    s_waitcnt lgkmcnt(7)
    v_mfma_f32_32x32x16_bf16 v[64:79], v[208:211], v[176:179], v[64:79]
    ds_read_b128 v[208:211], v228 offset:40960
    v_max3_f32 v248, v248, v48, v49
    v_max3_f32 v248, v248, v50, v51
    s_waitcnt lgkmcnt(7)
    v_mfma_f32_32x32x16_bf16 v[64:79], v[212:215], v[180:183], v[64:79]
    ds_read_b128 v[212:215], v229 offset:40960
    v_max3_f32 v248, v248, v52, v53
    v_max3_f32 v248, v248, v54, v55
    s_waitcnt lgkmcnt(7)
    v_mfma_f32_32x32x16_bf16 v[64:79], v[216:219], v[184:187], v[64:79]
    ds_read_b128 v[216:219], v230 offset:40960
    v_max3_f32 v248, v248, v56, v57
    v_max3_f32 v248, v248, v58, v59
    s_waitcnt lgkmcnt(7)
    v_mfma_f32_32x32x16_bf16 v[64:79], v[220:223], v[188:191], v[64:79]
    ds_read_b128 v[220:223], v231 offset:40960
    v_max3_f32 v248, v248, v60, v61
    v_max3_f32 v248, v248, v62, v63
    s_barrier
    s_waitcnt lgkmcnt(7)
    v_mfma_f32_32x32x16_bf16 v[80:95], v[192:195], v[160:163], 0
    ds_read_b128 v[192:195], v224 offset:49152
    s_waitcnt lgkmcnt(7)
    v_mfma_f32_32x32x16_bf16 v[80:95], v[196:199], v[164:167], v[80:95]
    ds_read_b128 v[196:199], v225 offset:49152
    s_waitcnt lgkmcnt(7)
    v_mfma_f32_32x32x16_bf16 v[80:95], v[200:203], v[168:171], v[80:95]
    ds_read_b128 v[200:203], v226 offset:49152
    s_waitcnt lgkmcnt(7)
    v_mfma_f32_32x32x16_bf16 v[80:95], v[204:207], v[172:175], v[80:95]
    ds_read_b128 v[204:207], v227 offset:49152
    s_waitcnt lgkmcnt(7)
    v_mfma_f32_32x32x16_bf16 v[80:95], v[208:211], v[176:179], v[80:95]
    ds_read_b128 v[208:211], v228 offset:49152
    v_max3_f32 v248, v248, v64, v65
    v_max3_f32 v248, v248, v66, v67
    s_waitcnt lgkmcnt(7)
    v_mfma_f32_32x32x16_bf16 v[80:95], v[212:215], v[180:183], v[80:95]
    ds_read_b128 v[212:215], v229 offset:49152
    v_max3_f32 v248, v248, v68, v69
    v_max3_f32 v248, v248, v70, v71
    s_waitcnt lgkmcnt(7)
    v_mfma_f32_32x32x16_bf16 v[80:95], v[216:219], v[184:187], v[80:95]
    ds_read_b128 v[216:219], v230 offset:49152
    v_max3_f32 v248, v248, v72, v73
    v_max3_f32 v248, v248, v74, v75
    s_waitcnt lgkmcnt(7)
    v_mfma_f32_32x32x16_bf16 v[80:95], v[220:223], v[188:191], v[80:95]
    ds_read_b128 v[220:223], v231 offset:49152
    v_max3_f32 v248, v248, v76, v77
    v_max3_f32 v248, v248, v78, v79
    s_barrier
    s_waitcnt lgkmcnt(7)
    v_mfma_f32_32x32x16_bf16 v[96:111], v[192:195], v[160:163], 0
    ds_read_b128 v[192:195], v224 offset:57344
    s_waitcnt lgkmcnt(7)
    v_mfma_f32_32x32x16_bf16 v[96:111], v[196:199], v[164:167], v[96:111]
    ds_read_b128 v[196:199], v225 offset:57344
    s_waitcnt lgkmcnt(7)
    v_mfma_f32_32x32x16_bf16 v[96:111], v[200:203], v[168:171], v[96:111]
    ds_read_b128 v[200:203], v226 offset:57344
    s_waitcnt lgkmcnt(7)
    v_mfma_f32_32x32x16_bf16 v[96:111], v[204:207], v[172:175], v[96:111]
    ds_read_b128 v[204:207], v227 offset:57344
    s_waitcnt lgkmcnt(7)
    v_mfma_f32_32x32x16_bf16 v[96:111], v[208:211], v[176:179], v[96:111]
    ds_read_b128 v[208:211], v228 offset:57344
    v_max3_f32 v248, v248, v80, v81
    v_max3_f32 v248, v248, v82, v83
    s_waitcnt lgkmcnt(7)
    v_mfma_f32_32x32x16_bf16 v[96:111], v[212:215], v[180:183], v[96:111]
    ds_read_b128 v[212:215], v229 offset:57344
    v_max3_f32 v248, v248, v84, v85
    v_max3_f32 v248, v248, v86, v87
    s_waitcnt lgkmcnt(7)
    v_mfma_f32_32x32x16_bf16 v[96:111], v[216:219], v[184:187], v[96:111]
    ds_read_b128 v[216:219], v230 offset:57344
    v_max3_f32 v248, v248, v88, v89
    v_max3_f32 v248, v248, v90, v91
    s_waitcnt lgkmcnt(7)
    v_mfma_f32_32x32x16_bf16 v[96:111], v[220:223], v[188:191], v[96:111]
    ds_read_b128 v[220:223], v231 offset:57344
    v_max3_f32 v248, v248, v92, v93
    v_max3_f32 v248, v248, v94, v95
    s_barrier
    s_waitcnt lgkmcnt(7)
    v_mfma_f32_32x32x16_bf16 v[112:127], v[192:195], v[160:163], 0
    v_add_u32 v224, 0x10000, v224
    v_add_u32 v225, 0x10000, v225
    v_add_u32 v226, 0x10000, v226
    v_add_u32 v227, 0x10000, v227
    v_add_u32 v228, 0x10000, v228
    v_add_u32 v229, 0x10000, v229
    v_add_u32 v230, 0x10000, v230
    v_add_u32 v231, 0x10000, v231
    ds_read_b128 v[192:195], v224 offset:0
    s_waitcnt lgkmcnt(7)
    v_mfma_f32_32x32x16_bf16 v[112:127], v[196:199], v[164:167], v[112:127]
    ds_read_b128 v[196:199], v225 offset:0
    s_waitcnt lgkmcnt(7)
    v_mfma_f32_32x32x16_bf16 v[112:127], v[200:203], v[168:171], v[112:127]
    ds_read_b128 v[200:203], v226 offset:0
    s_waitcnt lgkmcnt(7)
    v_mfma_f32_32x32x16_bf16 v[112:127], v[204:207], v[172:175], v[112:127]
    ds_read_b128 v[204:207], v227 offset:0
    s_waitcnt lgkmcnt(7)
    v_mfma_f32_32x32x16_bf16 v[112:127], v[208:211], v[176:179], v[112:127]
    ds_read_b128 v[208:211], v228 offset:0
    v_max3_f32 v248, v248, v96, v97
    v_max3_f32 v248, v248, v98, v99
    s_waitcnt lgkmcnt(7)
    v_mfma_f32_32x32x16_bf16 v[112:127], v[212:215], v[180:183], v[112:127]
    ds_read_b128 v[212:215], v229 offset:0
    v_max3_f32 v248, v248, v100, v101
    v_max3_f32 v248, v248, v102, v103
    s_waitcnt lgkmcnt(7)
    v_mfma_f32_32x32x16_bf16 v[112:127], v[216:219], v[184:187], v[112:127]
    ds_read_b128 v[216:219], v230 offset:0
    v_max3_f32 v248, v248, v104, v105
    v_max3_f32 v248, v248, v106, v107
    s_waitcnt lgkmcnt(7)
    v_mfma_f32_32x32x16_bf16 v[112:127], v[220:223], v[188:191], v[112:127]
    ds_read_b128 v[220:223], v231 offset:0
    v_max3_f32 v248, v248, v108, v109
    v_max3_f32 v248, v248, v110, v111
    s_barrier
    s_waitcnt lgkmcnt(7)
    v_mfma_f32_32x32x16_bf16 v[128:143], v[192:195], v[160:163], 0
    ds_read_b128 v[192:195], v224 offset:8192
    s_waitcnt lgkmcnt(7)
    v_mfma_f32_32x32x16_bf16 v[128:143], v[196:199], v[164:167], v[128:143]
    ds_read_b128 v[196:199], v225 offset:8192
    s_waitcnt lgkmcnt(7)
    v_mfma_f32_32x32x16_bf16 v[128:143], v[200:203], v[168:171], v[128:143]
    ds_read_b128 v[200:203], v226 offset:8192
    s_waitcnt lgkmcnt(7)
    v_mfma_f32_32x32x16_bf16 v[128:143], v[204:207], v[172:175], v[128:143]
    ds_read_b128 v[204:207], v227 offset:8192
    s_waitcnt lgkmcnt(7)
    v_mfma_f32_32x32x16_bf16 v[128:143], v[208:211], v[176:179], v[128:143]
    ds_read_b128 v[208:211], v228 offset:8192
    v_max3_f32 v248, v248, v112, v113
    v_max3_f32 v248, v248, v114, v115
    s_waitcnt lgkmcnt(7)
    v_mfma_f32_32x32x16_bf16 v[128:143], v[212:215], v[180:183], v[128:143]
    ds_read_b128 v[212:215], v229 offset:8192
    v_max3_f32 v248, v248, v116, v117
    v_max3_f32 v248, v248, v118, v119
    s_waitcnt lgkmcnt(7)
    v_mfma_f32_32x32x16_bf16 v[128:143], v[216:219], v[184:187], v[128:143]
    ds_read_b128 v[216:219], v230 offset:8192
    v_max3_f32 v248, v248, v120, v121
    v_max3_f32 v248, v248, v122, v123
    s_waitcnt lgkmcnt(7)
    v_mfma_f32_32x32x16_bf16 v[128:143], v[220:223], v[188:191], v[128:143]
    ds_read_b128 v[220:223], v231 offset:8192
    v_max3_f32 v248, v248, v124, v125
    v_max3_f32 v248, v248, v126, v127
    s_waitcnt lgkmcnt(7)
    v_mfma_f32_32x32x16_bf16 v[144:159], v[192:195], v[160:163], 0
    s_waitcnt lgkmcnt(6)
    v_mfma_f32_32x32x16_bf16 v[144:159], v[196:199], v[164:167], v[144:159]
    s_waitcnt lgkmcnt(5)
    v_mfma_f32_32x32x16_bf16 v[144:159], v[200:203], v[168:171], v[144:159]
    s_waitcnt lgkmcnt(4)
    v_mfma_f32_32x32x16_bf16 v[144:159], v[204:207], v[172:175], v[144:159]
    s_waitcnt lgkmcnt(3)
    v_mfma_f32_32x32x16_bf16 v[144:159], v[208:211], v[176:179], v[144:159]
    v_max3_f32 v248, v248, v128, v129
    v_max3_f32 v248, v248, v130, v131
    s_waitcnt lgkmcnt(2)
    v_mfma_f32_32x32x16_bf16 v[144:159], v[212:215], v[180:183], v[144:159]
    v_max3_f32 v248, v248, v132, v133
    v_max3_f32 v248, v248, v134, v135
    s_waitcnt lgkmcnt(1)
    v_mfma_f32_32x32x16_bf16 v[144:159], v[216:219], v[184:187], v[144:159]
    v_max3_f32 v248, v248, v136, v137
    v_max3_f32 v248, v248, v138, v139
    s_waitcnt lgkmcnt(0)
    v_mfma_f32_32x32x16_bf16 v[144:159], v[220:223], v[188:191], v[144:159]
    v_max3_f32 v248, v248, v140, v141
    v_max3_f32 v248, v248, v142, v143
    s_nop 9
    v_max3_f32 v248, v248, v144, v145
    v_max3_f32 v248, v248, v146, v147
    v_max3_f32 v248, v248, v148, v149
    v_max3_f32 v248, v248, v150, v151
    v_max3_f32 v248, v248, v152, v153
    v_max3_f32 v248, v248, v154, v155
    v_max3_f32 v248, v248, v156, v157
    v_max3_f32 v248, v248, v158, v159
    v_mov_b32 v252, v248
    s_nop 0
    s_nop 0
    v_permlane32_swap_b32 v248, v252
    v_max_f32 v248, v248, v252
    v_mul_f32 v248, 0xbe0293ee, v248
    s_nop 15
    s_branch L_common
L_bpre:
    s_nop 15
    s_waitcnt vmcnt(8)
    s_barrier
    s_add_u32 m0, s39, 40960
    s_add_u32 s41, s48, 40960
    s_cmp_ge_u32 s41, 81920
    s_cselect_b32 s49, 81920, 0
    s_sub_u32 s41, s41, s49
    s_add_u32 s41, s41, s39
    buffer_load_dwordx4 v232, s[24:27], s41 offen lds
    s_add_u32 m0, s39, 41984
    s_add_u32 s41, s41, 1024
    buffer_load_dwordx4 v233, s[24:27], s41 offen lds
    s_waitcnt vmcnt(8)
    s_barrier
    s_add_u32 m0, s39, 49152
    s_add_u32 s41, s48, 49152
    s_cmp_ge_u32 s41, 81920
    s_cselect_b32 s49, 81920, 0
    s_sub_u32 s41, s41, s49
    s_add_u32 s41, s41, s39
    buffer_load_dwordx4 v232, s[24:27], s41 offen lds
    s_add_u32 m0, s39, 50176
    s_add_u32 s41, s41, 1024
    buffer_load_dwordx4 v233, s[24:27], s41 offen lds
    s_waitcnt vmcnt(8)
    s_barrier
    s_add_u32 m0, s39, 57344
    s_add_u32 s41, s48, 57344
    s_cmp_ge_u32 s41, 81920
    s_cselect_b32 s49, 81920, 0
    s_sub_u32 s41, s41, s49
    s_add_u32 s41, s41, s39
    buffer_load_dwordx4 v232, s[24:27], s41 offen lds
    s_add_u32 m0, s39, 58368
    s_add_u32 s41, s41, 1024
    buffer_load_dwordx4 v233, s[24:27], s41 offen lds
    s_waitcnt vmcnt(8)
    s_barrier
    s_add_u32 m0, s39, 65536
    s_add_u32 s41, s48, 65536
    s_cmp_ge_u32 s41, 81920
    s_cselect_b32 s49, 81920, 0
    s_sub_u32 s41, s41, s49
    s_add_u32 s41, s41, s39
    buffer_load_dwordx4 v232, s[24:27], s41 offen lds
    s_add_u32 m0, s39, 66560
    s_add_u32 s41, s41, 1024
    buffer_load_dwordx4 v233, s[24:27], s41 offen lds
    s_waitcnt vmcnt(8)
    s_barrier
    s_add_u32 m0, s39, 73728
    s_add_u32 s41, s48, 73728
    s_cmp_ge_u32 s41, 81920
    s_cselect_b32 s49, 81920, 0
    s_sub_u32 s41, s41, s49
    s_add_u32 s41, s41, s39
    buffer_load_dwordx4 v232, s[24:27], s41 offen lds
    s_add_u32 m0, s39, 74752
    s_add_u32 s41, s41, 1024
    buffer_load_dwordx4 v233, s[24:27], s41 offen lds
    s_waitcnt vmcnt(8)
    s_barrier
    buffer_load_dwordx4 v[160:163], v250, s[20:23], 0 offen offset:0
    buffer_load_dwordx4 v[164:167], v250, s[20:23], 0 offen offset:32
    s_waitcnt vmcnt(8)
    s_barrier
    buffer_load_dwordx4 v[168:171], v250, s[20:23], 0 offen offset:64
    buffer_load_dwordx4 v[172:175], v250, s[20:23], 0 offen offset:96
    s_waitcnt vmcnt(8)
    s_barrier
    buffer_load_dwordx4 v[176:179], v250, s[20:23], 0 offen offset:128
    buffer_load_dwordx4 v[180:183], v250, s[20:23], 0 offen offset:160
    s_waitcnt vmcnt(8)
    s_barrier
    buffer_load_dwordx4 v[184:187], v250, s[20:23], 0 offen offset:192
    buffer_load_dwordx4 v[188:191], v250, s[20:23], 0 offen offset:224
    s_waitcnt vmcnt(8)
    s_barrier
    s_add_u32 m0, s39, 81920
    s_add_u32 s41, s48, 0
    s_cmp_ge_u32 s41, 81920
    s_cselect_b32 s49, 81920, 0
    s_sub_u32 s41, s41, s49
    s_add_u32 s41, s41, s39
    buffer_load_dwordx4 v254, s[28:31], s41 offen lds
    s_add_u32 m0, s39, 82944
    s_add_u32 s41, s41, 1024
    buffer_load_dwordx4 v253, s[28:31], s41 offen lds
    s_waitcnt vmcnt(8)
    s_add_u32 m0, s39, 90112
    s_add_u32 s41, s48, 8192
    s_cmp_ge_u32 s41, 81920
    s_cselect_b32 s49, 81920, 0
    s_sub_u32 s41, s41, s49
    s_add_u32 s41, s41, s39
    buffer_load_dwordx4 v254, s[28:31], s41 offen lds
    s_add_u32 m0, s39, 91136
    s_add_u32 s41, s41, 1024
    buffer_load_dwordx4 v253, s[28:31], s41 offen lds
    s_waitcnt vmcnt(8)
    s_add_u32 m0, s39, 98304
    s_add_u32 s41, s48, 16384
    s_cmp_ge_u32 s41, 81920
    s_cselect_b32 s49, 81920, 0
    s_sub_u32 s41, s41, s49
    s_add_u32 s41, s41, s39
    buffer_load_dwordx4 v254, s[28:31], s41 offen lds
    s_add_u32 m0, s39, 99328
    s_add_u32 s41, s41, 1024
    buffer_load_dwordx4 v253, s[28:31], s41 offen lds
    ds_read_b128 v[192:195], v224 offset:0
    ds_read_b128 v[196:199], v225 offset:0
    ds_read_b128 v[200:203], v226 offset:0
    ds_read_b128 v[204:207], v227 offset:0
    ds_read_b128 v[208:211], v224 offset:8192
    ds_read_b128 v[212:215], v225 offset:8192
    ds_read_b128 v[216:219], v226 offset:8192
    ds_read_b128 v[220:223], v227 offset:8192
    s_add_u32 m0, s39, 106496
    s_add_u32 s41, s48, 24576
    s_cmp_ge_u32 s41, 81920
    s_cselect_b32 s49, 81920, 0
    s_sub_u32 s41, s41, s49
    s_add_u32 s41, s41, s39
    buffer_load_dwordx4 v254, s[28:31], s41 offen lds
    s_add_u32 m0, s39, 107520
    s_add_u32 s41, s41, 1024
    buffer_load_dwordx4 v253, s[28:31], s41 offen lds
    s_waitcnt lgkmcnt(7)
    v_mfma_f32_32x32x16_bf16 v[0:15], v[192:195], v[160:163], 0
    ds_read_b128 v[192:195], v224 offset:16384
    s_waitcnt lgkmcnt(7)
    v_mfma_f32_32x32x16_bf16 v[0:15], v[196:199], v[164:167], v[0:15]
    ds_read_b128 v[196:199], v225 offset:16384
    s_waitcnt lgkmcnt(7)
    v_mfma_f32_32x32x16_bf16 v[0:15], v[200:203], v[168:171], v[0:15]
    ds_read_b128 v[200:203], v226 offset:16384
    s_waitcnt lgkmcnt(7)
    v_mfma_f32_32x32x16_bf16 v[0:15], v[204:207], v[172:175], v[0:15]
    ds_read_b128 v[204:207], v227 offset:16384
    s_waitcnt lgkmcnt(7)
    v_mfma_f32_32x32x16_bf16 v[16:31], v[208:211], v[160:163], 0
    ds_read_b128 v[208:211], v224 offset:24576
    s_waitcnt lgkmcnt(7)
    v_mfma_f32_32x32x16_bf16 v[16:31], v[212:215], v[164:167], v[16:31]
    ds_read_b128 v[212:215], v225 offset:24576
    s_waitcnt lgkmcnt(7)
    v_mfma_f32_32x32x16_bf16 v[16:31], v[216:219], v[168:171], v[16:31]
    ds_read_b128 v[216:219], v226 offset:24576
    s_waitcnt lgkmcnt(7)
    v_mfma_f32_32x32x16_bf16 v[16:31], v[220:223], v[172:175], v[16:31]
    ds_read_b128 v[220:223], v227 offset:24576
    s_add_u32 m0, s39, 114688
    s_add_u32 s41, s48, 32768
    s_cmp_ge_u32 s41, 81920
    s_cselect_b32 s49, 81920, 0
    s_sub_u32 s41, s41, s49
    s_add_u32 s41, s41, s39
    buffer_load_dwordx4 v254, s[28:31], s41 offen lds
    s_add_u32 m0, s39, 115712
    s_add_u32 s41, s41, 1024
    buffer_load_dwordx4 v253, s[28:31], s41 offen lds
    s_waitcnt lgkmcnt(7)
    v_mfma_f32_32x32x16_bf16 v[32:47], v[192:195], v[160:163], 0
    ds_read_b128 v[192:195], v224 offset:32768
    s_waitcnt lgkmcnt(7)
    v_mfma_f32_32x32x16_bf16 v[32:47], v[196:199], v[164:167], v[32:47]
    ds_read_b128 v[196:199], v225 offset:32768
    s_waitcnt lgkmcnt(7)
    v_mfma_f32_32x32x16_bf16 v[32:47], v[200:203], v[168:171], v[32:47]
    ds_read_b128 v[200:203], v226 offset:32768
    s_waitcnt lgkmcnt(7)
    v_mfma_f32_32x32x16_bf16 v[32:47], v[204:207], v[172:175], v[32:47]
    ds_read_b128 v[204:207], v227 offset:32768
    s_waitcnt lgkmcnt(7)
    v_mfma_f32_32x32x16_bf16 v[48:63], v[208:211], v[160:163], 0
    ds_read_b128 v[208:211], v224 offset:40960
    s_waitcnt lgkmcnt(7)
    v_mfma_f32_32x32x16_bf16 v[48:63], v[212:215], v[164:167], v[48:63]
    ds_read_b128 v[212:215], v225 offset:40960
    s_waitcnt lgkmcnt(7)
    v_mfma_f32_32x32x16_bf16 v[48:63], v[216:219], v[168:171], v[48:63]
    ds_read_b128 v[216:219], v226 offset:40960
    s_waitcnt lgkmcnt(7)
    v_mfma_f32_32x32x16_bf16 v[48:63], v[220:223], v[172:175], v[48:63]
    ds_read_b128 v[220:223], v227 offset:40960
    s_add_u32 m0, s39, 122880
    s_add_u32 s41, s48, 40960
    s_cmp_ge_u32 s41, 81920
    s_cselect_b32 s49, 81920, 0
    s_sub_u32 s41, s41, s49
    s_add_u32 s41, s41, s39
    buffer_load_dwordx4 v254, s[28:31], s41 offen lds
    s_add_u32 m0, s39, 123904
    s_add_u32 s41, s41, 1024
    buffer_load_dwordx4 v253, s[28:31], s41 offen lds
    s_waitcnt lgkmcnt(7)
    v_mfma_f32_32x32x16_bf16 v[64:79], v[192:195], v[160:163], 0
    ds_read_b128 v[192:195], v224 offset:49152
    s_waitcnt lgkmcnt(7)
    v_mfma_f32_32x32x16_bf16 v[64:79], v[196:199], v[164:167], v[64:79]
    ds_read_b128 v[196:199], v225 offset:49152
    s_waitcnt lgkmcnt(7)
    v_mfma_f32_32x32x16_bf16 v[64:79], v[200:203], v[168:171], v[64:79]
    ds_read_b128 v[200:203], v226 offset:49152
    s_waitcnt lgkmcnt(7)
    v_mfma_f32_32x32x16_bf16 v[64:79], v[204:207], v[172:175], v[64:79]
    ds_read_b128 v[204:207], v227 offset:49152
    s_waitcnt lgkmcnt(7)
    v_mfma_f32_32x32x16_bf16 v[80:95], v[208:211], v[160:163], 0
    ds_read_b128 v[208:211], v224 offset:57344
    s_waitcnt lgkmcnt(7)
    v_mfma_f32_32x32x16_bf16 v[80:95], v[212:215], v[164:167], v[80:95]
    ds_read_b128 v[212:215], v225 offset:57344
    s_waitcnt lgkmcnt(7)
    v_mfma_f32_32x32x16_bf16 v[80:95], v[216:219], v[168:171], v[80:95]
    ds_read_b128 v[216:219], v226 offset:57344
    s_waitcnt lgkmcnt(7)
    v_mfma_f32_32x32x16_bf16 v[80:95], v[220:223], v[172:175], v[80:95]
    ds_read_b128 v[220:223], v227 offset:57344
    s_add_u32 m0, s39, 131072
    s_add_u32 s41, s48, 49152
    s_cmp_ge_u32 s41, 81920
    s_cselect_b32 s49, 81920, 0
    s_sub_u32 s41, s41, s49
    s_add_u32 s41, s41, s39
    buffer_load_dwordx4 v254, s[28:31], s41 offen lds
    s_add_u32 m0, s39, 132096
    s_add_u32 s41, s41, 1024
    buffer_load_dwordx4 v253, s[28:31], s41 offen lds
    s_waitcnt lgkmcnt(7)
    v_mfma_f32_32x32x16_bf16 v[96:111], v[192:195], v[160:163], 0
    v_add_u32 v224, 0x10000, v224
    ds_read_b128 v[192:195], v224 offset:0
    s_waitcnt lgkmcnt(7)
    v_mfma_f32_32x32x16_bf16 v[96:111], v[196:199], v[164:167], v[96:111]
    v_add_u32 v225, 0x10000, v225
    ds_read_b128 v[196:199], v225 offset:0
    s_waitcnt lgkmcnt(7)
    v_mfma_f32_32x32x16_bf16 v[96:111], v[200:203], v[168:171], v[96:111]
    v_add_u32 v226, 0x10000, v226
    ds_read_b128 v[200:203], v226 offset:0
    s_waitcnt lgkmcnt(7)
    v_mfma_f32_32x32x16_bf16 v[96:111], v[204:207], v[172:175], v[96:111]
    v_add_u32 v227, 0x10000, v227
    ds_read_b128 v[204:207], v227 offset:0
    s_waitcnt lgkmcnt(7)
    v_mfma_f32_32x32x16_bf16 v[112:127], v[208:211], v[160:163], 0
    ds_read_b128 v[208:211], v224 offset:8192
    s_waitcnt lgkmcnt(7)
    v_mfma_f32_32x32x16_bf16 v[112:127], v[212:215], v[164:167], v[112:127]
    ds_read_b128 v[212:215], v225 offset:8192
    s_waitcnt lgkmcnt(7)
    v_mfma_f32_32x32x16_bf16 v[112:127], v[216:219], v[168:171], v[112:127]
    ds_read_b128 v[216:219], v226 offset:8192
    s_waitcnt lgkmcnt(7)
    v_mfma_f32_32x32x16_bf16 v[112:127], v[220:223], v[172:175], v[112:127]
    ds_read_b128 v[220:223], v227 offset:8192
    s_add_u32 m0, s39, 139264
    s_add_u32 s41, s48, 57344
    s_cmp_ge_u32 s41, 81920
    s_cselect_b32 s49, 81920, 0
    s_sub_u32 s41, s41, s49
    s_add_u32 s41, s41, s39
    buffer_load_dwordx4 v254, s[28:31], s41 offen lds
    s_add_u32 m0, s39, 140288
    s_add_u32 s41, s41, 1024
    buffer_load_dwordx4 v253, s[28:31], s41 offen lds
    s_waitcnt lgkmcnt(7)
    v_mfma_f32_32x32x16_bf16 v[128:143], v[192:195], v[160:163], 0
    ds_read_b128 v[192:195], v228 offset:0
    s_waitcnt lgkmcnt(7)
    v_mfma_f32_32x32x16_bf16 v[128:143], v[196:199], v[164:167], v[128:143]
    ds_read_b128 v[196:199], v229 offset:0
    s_waitcnt lgkmcnt(7)
    v_mfma_f32_32x32x16_bf16 v[128:143], v[200:203], v[168:171], v[128:143]
    ds_read_b128 v[200:203], v230 offset:0
    s_waitcnt lgkmcnt(7)
    v_mfma_f32_32x32x16_bf16 v[128:143], v[204:207], v[172:175], v[128:143]
    ds_read_b128 v[204:207], v231 offset:0
    s_waitcnt lgkmcnt(7)
    v_mfma_f32_32x32x16_bf16 v[144:159], v[208:211], v[160:163], 0
    ds_read_b128 v[208:211], v228 offset:8192
    s_waitcnt lgkmcnt(7)
    v_mfma_f32_32x32x16_bf16 v[144:159], v[212:215], v[164:167], v[144:159]
    ds_read_b128 v[212:215], v229 offset:8192
    s_waitcnt lgkmcnt(7)
    v_mfma_f32_32x32x16_bf16 v[144:159], v[216:219], v[168:171], v[144:159]
    ds_read_b128 v[216:219], v230 offset:8192
    s_waitcnt lgkmcnt(7)
    v_mfma_f32_32x32x16_bf16 v[144:159], v[220:223], v[172:175], v[144:159]
    ds_read_b128 v[220:223], v231 offset:8192
    s_add_u32 m0, s39, 147456
    s_add_u32 s41, s48, 65536
    s_cmp_ge_u32 s41, 81920
    s_cselect_b32 s49, 81920, 0
    s_sub_u32 s41, s41, s49
    s_add_u32 s41, s41, s39
    buffer_load_dwordx4 v254, s[28:31], s41 offen lds
    s_add_u32 m0, s39, 148480
    s_add_u32 s41, s41, 1024
    buffer_load_dwordx4 v253, s[28:31], s41 offen lds
    s_waitcnt vmcnt(18)
    s_waitcnt lgkmcnt(7)
    v_mfma_f32_32x32x16_bf16 v[0:15], v[192:195], v[176:179], v[0:15]
    ds_read_b128 v[192:195], v228 offset:16384
    s_waitcnt lgkmcnt(7)
    v_mfma_f32_32x32x16_bf16 v[0:15], v[196:199], v[180:183], v[0:15]
    ds_read_b128 v[196:199], v229 offset:16384
    s_waitcnt lgkmcnt(7)
    v_mfma_f32_32x32x16_bf16 v[0:15], v[200:203], v[184:187], v[0:15]
    ds_read_b128 v[200:203], v230 offset:16384
    s_waitcnt lgkmcnt(7)
    v_mfma_f32_32x32x16_bf16 v[0:15], v[204:207], v[188:191], v[0:15]
    ds_read_b128 v[204:207], v231 offset:16384
    s_waitcnt lgkmcnt(7)
    v_mfma_f32_32x32x16_bf16 v[16:31], v[208:211], v[176:179], v[16:31]
    ds_read_b128 v[208:211], v228 offset:24576
    s_waitcnt lgkmcnt(7)
    v_mfma_f32_32x32x16_bf16 v[16:31], v[212:215], v[180:183], v[16:31]
    ds_read_b128 v[212:215], v229 offset:24576
    s_nop 4
    v_max3_f32 v248, v248, v0, v1
    v_max3_f32 v248, v248, v2, v3
    s_waitcnt lgkmcnt(7)
    v_mfma_f32_32x32x16_bf16 v[16:31], v[216:219], v[184:187], v[16:31]
    ds_read_b128 v[216:219], v230 offset:24576
    v_max3_f32 v248, v248, v4, v5
    v_max3_f32 v248, v248, v6, v7
    s_waitcnt lgkmcnt(7)
    v_mfma_f32_32x32x16_bf16 v[16:31], v[220:223], v[188:191], v[16:31]
    ds_read_b128 v[220:223], v231 offset:24576
    v_max3_f32 v248, v248, v8, v9
    v_max3_f32 v248, v248, v10, v11
    v_max3_f32 v248, v248, v12, v13
    v_max3_f32 v248, v248, v14, v15
    s_add_u32 m0, s39, 155648
    s_add_u32 s41, s48, 73728
    s_cmp_ge_u32 s41, 81920
    s_cselect_b32 s49, 81920, 0
    s_sub_u32 s41, s41, s49
    s_add_u32 s41, s41, s39
    buffer_load_dwordx4 v254, s[28:31], s41 offen lds
    s_add_u32 m0, s39, 156672
    s_add_u32 s41, s41, 1024
    buffer_load_dwordx4 v253, s[28:31], s41 offen lds
    s_waitcnt lgkmcnt(7)
    v_mfma_f32_32x32x16_bf16 v[32:47], v[192:195], v[176:179], v[32:47]
    ds_read_b128 v[192:195], v228 offset:32768
    s_waitcnt lgkmcnt(7)
    v_mfma_f32_32x32x16_bf16 v[32:47], v[196:199], v[180:183], v[32:47]
    ds_read_b128 v[196:199], v229 offset:32768
    v_max3_f32 v248, v248, v16, v17
    v_max3_f32 v248, v248, v18, v19
    s_waitcnt lgkmcnt(7)
    v_mfma_f32_32x32x16_bf16 v[32:47], v[200:203], v[184:187], v[32:47]
    ds_read_b128 v[200:203], v230 offset:32768
    v_max3_f32 v248, v248, v20, v21
    v_max3_f32 v248, v248, v22, v23
    s_waitcnt lgkmcnt(7)
    v_mfma_f32_32x32x16_bf16 v[32:47], v[204:207], v[188:191], v[32:47]
    ds_read_b128 v[204:207], v231 offset:32768
    v_max3_f32 v248, v248, v24, v25
    v_max3_f32 v248, v248, v26, v27
    v_max3_f32 v248, v248, v28, v29
    v_max3_f32 v248, v248, v30, v31
    s_waitcnt lgkmcnt(7)
    v_mfma_f32_32x32x16_bf16 v[48:63], v[208:211], v[176:179], v[48:63]
    ds_read_b128 v[208:211], v228 offset:40960
    s_waitcnt lgkmcnt(7)
    v_mfma_f32_32x32x16_bf16 v[48:63], v[212:215], v[180:183], v[48:63]
    ds_read_b128 v[212:215], v229 offset:40960
    s_nop 0
    v_max3_f32 v248, v248, v32, v33
    v_max3_f32 v248, v248, v34, v35
    s_waitcnt lgkmcnt(7)
    v_mfma_f32_32x32x16_bf16 v[48:63], v[216:219], v[184:187], v[48:63]
    ds_read_b128 v[216:219], v230 offset:40960
    v_max3_f32 v248, v248, v36, v37
    v_max3_f32 v248, v248, v38, v39
    s_waitcnt lgkmcnt(7)
    v_mfma_f32_32x32x16_bf16 v[48:63], v[220:223], v[188:191], v[48:63]
    ds_read_b128 v[220:223], v231 offset:40960
    v_max3_f32 v248, v248, v40, v41
    v_max3_f32 v248, v248, v42, v43
    v_max3_f32 v248, v248, v44, v45
    v_max3_f32 v248, v248, v46, v47
    s_waitcnt lgkmcnt(7)
    v_mfma_f32_32x32x16_bf16 v[64:79], v[192:195], v[176:179], v[64:79]
    ds_read_b128 v[192:195], v228 offset:49152
    s_waitcnt lgkmcnt(7)
    v_mfma_f32_32x32x16_bf16 v[64:79], v[196:199], v[180:183], v[64:79]
    ds_read_b128 v[196:199], v229 offset:49152
    s_nop 0
    v_max3_f32 v248, v248, v48, v49
    v_max3_f32 v248, v248, v50, v51
    s_waitcnt lgkmcnt(7)
    v_mfma_f32_32x32x16_bf16 v[64:79], v[200:203], v[184:187], v[64:79]
    ds_read_b128 v[200:203], v230 offset:49152
    v_max3_f32 v248, v248, v52, v53
    v_max3_f32 v248, v248, v54, v55
    s_waitcnt lgkmcnt(7)
    v_mfma_f32_32x32x16_bf16 v[64:79], v[204:207], v[188:191], v[64:79]
    ds_read_b128 v[204:207], v231 offset:49152
    v_max3_f32 v248, v248, v56, v57
    v_max3_f32 v248, v248, v58, v59
    v_max3_f32 v248, v248, v60, v61
    v_max3_f32 v248, v248, v62, v63
    s_waitcnt lgkmcnt(7)
    v_mfma_f32_32x32x16_bf16 v[80:95], v[208:211], v[176:179], v[80:95]
    ds_read_b128 v[208:211], v228 offset:57344
    s_waitcnt lgkmcnt(7)
    v_mfma_f32_32x32x16_bf16 v[80:95], v[212:215], v[180:183], v[80:95]
    ds_read_b128 v[212:215], v229 offset:57344
    s_nop 0
    v_max3_f32 v248, v248, v64, v65
    v_max3_f32 v248, v248, v66, v67
    s_waitcnt lgkmcnt(7)
    v_mfma_f32_32x32x16_bf16 v[80:95], v[216:219], v[184:187], v[80:95]
    ds_read_b128 v[216:219], v230 offset:57344
    v_max3_f32 v248, v248, v68, v69
    v_max3_f32 v248, v248, v70, v71
    s_waitcnt lgkmcnt(7)
    v_mfma_f32_32x32x16_bf16 v[80:95], v[220:223], v[188:191], v[80:95]
    ds_read_b128 v[220:223], v231 offset:57344
    v_max3_f32 v248, v248, v72, v73
    v_max3_f32 v248, v248, v74, v75
    v_max3_f32 v248, v248, v76, v77
    v_max3_f32 v248, v248, v78, v79
    s_waitcnt lgkmcnt(7)
    v_mfma_f32_32x32x16_bf16 v[96:111], v[192:195], v[176:179], v[96:111]
    v_add_u32 v228, 0x10000, v228
    ds_read_b128 v[192:195], v228 offset:0
    s_waitcnt lgkmcnt(7)
    v_mfma_f32_32x32x16_bf16 v[96:111], v[196:199], v[180:183], v[96:111]
    v_add_u32 v229, 0x10000, v229
    ds_read_b128 v[196:199], v229 offset:0
    v_max3_f32 v248, v248, v80, v81
    v_max3_f32 v248, v248, v82, v83
    s_waitcnt lgkmcnt(7)
    v_mfma_f32_32x32x16_bf16 v[96:111], v[200:203], v[184:187], v[96:111]
    v_add_u32 v230, 0x10000, v230
    ds_read_b128 v[200:203], v230 offset:0
    v_max3_f32 v248, v248, v84, v85
    v_max3_f32 v248, v248, v86, v87
    s_waitcnt lgkmcnt(7)
    v_mfma_f32_32x32x16_bf16 v[96:111], v[204:207], v[188:191], v[96:111]
    v_add_u32 v231, 0x10000, v231
    ds_read_b128 v[204:207], v231 offset:0
    v_max3_f32 v248, v248, v88, v89
    v_max3_f32 v248, v248, v90, v91
    v_max3_f32 v248, v248, v92, v93
    v_max3_f32 v248, v248, v94, v95
    s_waitcnt lgkmcnt(7)
    v_mfma_f32_32x32x16_bf16 v[112:127], v[208:211], v[176:179], v[112:127]
    ds_read_b128 v[208:211], v228 offset:8192
    s_waitcnt lgkmcnt(7)
    v_mfma_f32_32x32x16_bf16 v[112:127], v[212:215], v[180:183], v[112:127]
    ds_read_b128 v[212:215], v229 offset:8192
    v_max3_f32 v248, v248, v96, v97
    v_max3_f32 v248, v248, v98, v99
    s_waitcnt lgkmcnt(7)
    v_mfma_f32_32x32x16_bf16 v[112:127], v[216:219], v[184:187], v[112:127]
    ds_read_b128 v[216:219], v230 offset:8192
    v_max3_f32 v248, v248, v100, v101
    v_max3_f32 v248, v248, v102, v103
    s_waitcnt lgkmcnt(7)
    v_mfma_f32_32x32x16_bf16 v[112:127], v[220:223], v[188:191], v[112:127]
    ds_read_b128 v[220:223], v231 offset:8192
    v_max3_f32 v248, v248, v104, v105
    v_max3_f32 v248, v248, v106, v107
    v_max3_f32 v248, v248, v108, v109
    v_max3_f32 v248, v248, v110, v111
    s_waitcnt lgkmcnt(7)
    v_mfma_f32_32x32x16_bf16 v[128:143], v[192:195], v[176:179], v[128:143]
    s_waitcnt lgkmcnt(6)
    v_mfma_f32_32x32x16_bf16 v[128:143], v[196:199], v[180:183], v[128:143]
    s_nop 2
    v_max3_f32 v248, v248, v112, v113
    v_max3_f32 v248, v248, v114, v115
    s_waitcnt lgkmcnt(5)
    v_mfma_f32_32x32x16_bf16 v[128:143], v[200:203], v[184:187], v[128:143]
    v_max3_f32 v248, v248, v116, v117
    v_max3_f32 v248, v248, v118, v119
    s_waitcnt lgkmcnt(4)
    v_mfma_f32_32x32x16_bf16 v[128:143], v[204:207], v[188:191], v[128:143]
    v_max3_f32 v248, v248, v120, v121
    v_max3_f32 v248, v248, v122, v123
    v_max3_f32 v248, v248, v124, v125
    v_max3_f32 v248, v248, v126, v127
    s_waitcnt lgkmcnt(3)
    v_mfma_f32_32x32x16_bf16 v[144:159], v[208:211], v[176:179], v[144:159]
    s_waitcnt lgkmcnt(2)
    v_mfma_f32_32x32x16_bf16 v[144:159], v[212:215], v[180:183], v[144:159]
    s_nop 3
    v_max3_f32 v248, v248, v128, v129
    v_max3_f32 v248, v248, v130, v131
    s_waitcnt lgkmcnt(1)
    v_mfma_f32_32x32x16_bf16 v[144:159], v[216:219], v[184:187], v[144:159]
    v_max3_f32 v248, v248, v132, v133
    v_max3_f32 v248, v248, v134, v135
    s_waitcnt lgkmcnt(0)
    v_mfma_f32_32x32x16_bf16 v[144:159], v[220:223], v[188:191], v[144:159]
    v_max3_f32 v248, v248, v136, v137
    v_max3_f32 v248, v248, v138, v139
    v_max3_f32 v248, v248, v140, v141
    v_max3_f32 v248, v248, v142, v143
    s_nop 7
    v_max3_f32 v248, v248, v144, v145
    v_max3_f32 v248, v248, v146, v147
    v_max3_f32 v248, v248, v148, v149
    v_max3_f32 v248, v248, v150, v151
    v_max3_f32 v248, v248, v152, v153
    v_max3_f32 v248, v248, v154, v155
    v_max3_f32 v248, v248, v156, v157
    v_max3_f32 v248, v248, v158, v159
    v_mov_b32 v252, v248
    s_nop 0
    s_nop 0
    v_permlane32_swap_b32 v248, v252
    v_max_f32 v248, v248, v252
    v_mul_f32 v248, 0xbe0293ee, v248
    s_waitcnt vmcnt(0)
    s_barrier
    s_nop 15
L_common:
    s_lshl_b32 s41, s36, 13
    v_lshlrev_b32 v252, 7, v251
    v_add_u32 v252, s41, v252
    v_min_u32 v252, L_end-L_pc, v252
    global_load_dword v223, v252, s[46:47]
    v_fmamk_f32 v0, v0, 0x3e0293ee, v248
    v_fmamk_f32 v1, v1, 0x3e0293ee, v248
    v_fmamk_f32 v2, v2, 0x3e0293ee, v248
    v_fmamk_f32 v3, v3, 0x3e0293ee, v248
    v_exp_f32 v0, v0
    v_fmamk_f32 v4, v4, 0x3e0293ee, v248
    v_exp_f32 v1, v1
    v_fmamk_f32 v5, v5, 0x3e0293ee, v248
    v_exp_f32 v2, v2
    v_fmamk_f32 v6, v6, 0x3e0293ee, v248
    v_exp_f32 v3, v3
    v_fmamk_f32 v7, v7, 0x3e0293ee, v248
    v_exp_f32 v4, v4
    v_cvt_pk_bf16_f32 v0, v0, v1
    v_exp_f32 v5, v5
    v_exp_f32 v6, v6
    v_cvt_pk_bf16_f32 v1, v2, v3
    v_exp_f32 v7, v7
    v_cvt_pk_bf16_f32 v2, v4, v5
    v_cvt_pk_bf16_f32 v3, v6, v7
    v_fmamk_f32 v8, v8, 0x3e0293ee, v248
    v_fmamk_f32 v9, v9, 0x3e0293ee, v248
    v_fmamk_f32 v10, v10, 0x3e0293ee, v248
    v_fmamk_f32 v11, v11, 0x3e0293ee, v248
    v_exp_f32 v8, v8
    v_fmamk_f32 v12, v12, 0x3e0293ee, v248
    v_exp_f32 v9, v9
    v_fmamk_f32 v13, v13, 0x3e0293ee, v248
    v_exp_f32 v10, v10
    v_fmamk_f32 v14, v14, 0x3e0293ee, v248
    v_exp_f32 v11, v11
    v_fmamk_f32 v15, v15, 0x3e0293ee, v248
    v_exp_f32 v12, v12
    v_cvt_pk_bf16_f32 v4, v8, v9
    v_exp_f32 v13, v13
    v_exp_f32 v14, v14
    v_cvt_pk_bf16_f32 v5, v10, v11
    v_exp_f32 v15, v15
    v_cvt_pk_bf16_f32 v6, v12, v13
    v_cvt_pk_bf16_f32 v7, v14, v15
    v_fmamk_f32 v16, v16, 0x3e0293ee, v248
    v_fmamk_f32 v17, v17, 0x3e0293ee, v248
    v_fmamk_f32 v18, v18, 0x3e0293ee, v248
    v_fmamk_f32 v19, v19, 0x3e0293ee, v248
    v_exp_f32 v16, v16
    v_fmamk_f32 v20, v20, 0x3e0293ee, v248
    v_exp_f32 v17, v17
    v_fmamk_f32 v21, v21, 0x3e0293ee, v248
    v_exp_f32 v18, v18
    v_fmamk_f32 v22, v22, 0x3e0293ee, v248
    v_exp_f32 v19, v19
    v_fmamk_f32 v23, v23, 0x3e0293ee, v248
    v_exp_f32 v20, v20
    v_cvt_pk_bf16_f32 v16, v16, v17
    v_exp_f32 v21, v21
    v_exp_f32 v22, v22
    v_cvt_pk_bf16_f32 v17, v18, v19
    v_exp_f32 v23, v23
    v_cvt_pk_bf16_f32 v18, v20, v21
    v_cvt_pk_bf16_f32 v19, v22, v23
    v_fmamk_f32 v24, v24, 0x3e0293ee, v248
    v_fmamk_f32 v25, v25, 0x3e0293ee, v248
    v_fmamk_f32 v26, v26, 0x3e0293ee, v248
    v_fmamk_f32 v27, v27, 0x3e0293ee, v248
    v_exp_f32 v24, v24
    v_fmamk_f32 v28, v28, 0x3e0293ee, v248
    v_exp_f32 v25, v25
    v_fmamk_f32 v29, v29, 0x3e0293ee, v248
    v_exp_f32 v26, v26
    v_fmamk_f32 v30, v30, 0x3e0293ee, v248
    v_exp_f32 v27, v27
    v_fmamk_f32 v31, v31, 0x3e0293ee, v248
    v_exp_f32 v28, v28
    v_cvt_pk_bf16_f32 v20, v24, v25
    v_exp_f32 v29, v29
    v_exp_f32 v30, v30
    v_cvt_pk_bf16_f32 v21, v26, v27
    v_exp_f32 v31, v31
    v_cvt_pk_bf16_f32 v22, v28, v29
    v_cvt_pk_bf16_f32 v23, v30, v31
    v_fmamk_f32 v32, v32, 0x3e0293ee, v248
    v_fmamk_f32 v33, v33, 0x3e0293ee, v248
    v_fmamk_f32 v34, v34, 0x3e0293ee, v248
    v_fmamk_f32 v35, v35, 0x3e0293ee, v248
    v_exp_f32 v32, v32
    v_fmamk_f32 v36, v36, 0x3e0293ee, v248
    v_exp_f32 v33, v33
    v_fmamk_f32 v37, v37, 0x3e0293ee, v248
    v_exp_f32 v34, v34
    v_fmamk_f32 v38, v38, 0x3e0293ee, v248
    v_exp_f32 v35, v35
    v_fmamk_f32 v39, v39, 0x3e0293ee, v248
    v_exp_f32 v36, v36
    v_cvt_pk_bf16_f32 v32, v32, v33
    v_exp_f32 v37, v37
    v_exp_f32 v38, v38
    v_cvt_pk_bf16_f32 v33, v34, v35
    v_exp_f32 v39, v39
    v_cvt_pk_bf16_f32 v34, v36, v37
    v_cvt_pk_bf16_f32 v35, v38, v39
    v_fmamk_f32 v40, v40, 0x3e0293ee, v248
    v_fmamk_f32 v41, v41, 0x3e0293ee, v248
    v_fmamk_f32 v42, v42, 0x3e0293ee, v248
    v_fmamk_f32 v43, v43, 0x3e0293ee, v248
    v_exp_f32 v40, v40
    v_fmamk_f32 v44, v44, 0x3e0293ee, v248
    v_exp_f32 v41, v41
    v_fmamk_f32 v45, v45, 0x3e0293ee, v248
    v_exp_f32 v42, v42
    v_fmamk_f32 v46, v46, 0x3e0293ee, v248
    v_exp_f32 v43, v43
    v_fmamk_f32 v47, v47, 0x3e0293ee, v248
    v_exp_f32 v44, v44
    v_cvt_pk_bf16_f32 v36, v40, v41
    v_exp_f32 v45, v45
    v_exp_f32 v46, v46
    v_cvt_pk_bf16_f32 v37, v42, v43
    v_exp_f32 v47, v47
    v_cvt_pk_bf16_f32 v38, v44, v45
    v_cvt_pk_bf16_f32 v39, v46, v47
    v_fmamk_f32 v48, v48, 0x3e0293ee, v248
    v_fmamk_f32 v49, v49, 0x3e0293ee, v248
    v_fmamk_f32 v50, v50, 0x3e0293ee, v248
    v_fmamk_f32 v51, v51, 0x3e0293ee, v248
    v_bfe_u32 v41, v251, 2, 1
    v_subrev_u32 v41, 1, v41
    v_and_b32 v40, 0x3f803f80, v41
    v_xor_b32 v42, 0x3f803f80, v40
    v_mov_b32 v41, v40
    v_mov_b32 v43, v42
    v_exp_f32 v48, v48
    v_fmamk_f32 v52, v52, 0x3e0293ee, v248
    v_exp_f32 v49, v49
    v_fmamk_f32 v53, v53, 0x3e0293ee, v248
    v_exp_f32 v50, v50
    v_fmamk_f32 v54, v54, 0x3e0293ee, v248
    v_exp_f32 v51, v51
    v_fmamk_f32 v55, v55, 0x3e0293ee, v248
    v_exp_f32 v52, v52
    v_cvt_pk_bf16_f32 v48, v48, v49
    v_exp_f32 v53, v53
    v_exp_f32 v54, v54
    v_cvt_pk_bf16_f32 v49, v50, v51
    v_exp_f32 v55, v55
    v_cvt_pk_bf16_f32 v50, v52, v53
    v_cvt_pk_bf16_f32 v51, v54, v55
    v_fmamk_f32 v56, v56, 0x3e0293ee, v248
    v_fmamk_f32 v57, v57, 0x3e0293ee, v248
    v_fmamk_f32 v58, v58, 0x3e0293ee, v248
    v_fmamk_f32 v59, v59, 0x3e0293ee, v248
    v_exp_f32 v56, v56
    v_fmamk_f32 v60, v60, 0x3e0293ee, v248
    v_exp_f32 v57, v57
    v_fmamk_f32 v61, v61, 0x3e0293ee, v248
    v_exp_f32 v58, v58
    v_fmamk_f32 v62, v62, 0x3e0293ee, v248
    v_exp_f32 v59, v59
    v_fmamk_f32 v63, v63, 0x3e0293ee, v248
    v_exp_f32 v60, v60
    v_cvt_pk_bf16_f32 v52, v56, v57
    v_exp_f32 v61, v61
    v_exp_f32 v62, v62
    v_cvt_pk_bf16_f32 v53, v58, v59
    v_exp_f32 v63, v63
    v_cvt_pk_bf16_f32 v54, v60, v61
    v_cvt_pk_bf16_f32 v55, v62, v63
    v_fmamk_f32 v64, v64, 0x3e0293ee, v248
    v_fmamk_f32 v65, v65, 0x3e0293ee, v248
    v_fmamk_f32 v66, v66, 0x3e0293ee, v248
    v_fmamk_f32 v67, v67, 0x3e0293ee, v248
    v_and_b32 v56, 1, v251
    v_mul_u32_u24 v56, 0xaaaa, v56
    v_add_u32 v56, 0x4444, v56
    v_mov_b32 v44, 0
    v_mov_b32 v45, 0
    v_mov_b32 v46, 0
    v_mov_b32 v47, 0
    v_exp_f32 v64, v64
    v_fmamk_f32 v68, v68, 0x3e0293ee, v248
    v_exp_f32 v65, v65
    v_fmamk_f32 v69, v69, 0x3e0293ee, v248
    v_exp_f32 v66, v66
    v_fmamk_f32 v70, v70, 0x3e0293ee, v248
    v_exp_f32 v67, v67
    v_fmamk_f32 v71, v71, 0x3e0293ee, v248
    v_exp_f32 v68, v68
    v_cvt_pk_bf16_f32 v64, v64, v65
    v_exp_f32 v69, v69
    v_exp_f32 v70, v70
    v_cvt_pk_bf16_f32 v65, v66, v67
    v_exp_f32 v71, v71
    v_cvt_pk_bf16_f32 v66, v68, v69
    v_cvt_pk_bf16_f32 v67, v70, v71
    v_fmamk_f32 v72, v72, 0x3e0293ee, v248
    v_fmamk_f32 v73, v73, 0x3e0293ee, v248
    v_fmamk_f32 v74, v74, 0x3e0293ee, v248
    v_fmamk_f32 v75, v75, 0x3e0293ee, v248
    v_exp_f32 v72, v72
    v_fmamk_f32 v76, v76, 0x3e0293ee, v248
    v_exp_f32 v73, v73
    v_fmamk_f32 v77, v77, 0x3e0293ee, v248
    v_exp_f32 v74, v74
    v_fmamk_f32 v78, v78, 0x3e0293ee, v248
    v_exp_f32 v75, v75
    v_fmamk_f32 v79, v79, 0x3e0293ee, v248
    v_exp_f32 v76, v76
    v_cvt_pk_bf16_f32 v68, v72, v73
    v_exp_f32 v77, v77
    v_exp_f32 v78, v78
    v_cvt_pk_bf16_f32 v69, v74, v75
    v_exp_f32 v79, v79
    v_cvt_pk_bf16_f32 v70, v76, v77
    v_cvt_pk_bf16_f32 v71, v78, v79
    v_fmamk_f32 v80, v80, 0x3e0293ee, v248
    v_fmamk_f32 v81, v81, 0x3e0293ee, v248
    v_fmamk_f32 v82, v82, 0x3e0293ee, v248
    v_fmamk_f32 v83, v83, 0x3e0293ee, v248
    v_exp_f32 v80, v80
    v_fmamk_f32 v84, v84, 0x3e0293ee, v248
    v_exp_f32 v81, v81
    v_fmamk_f32 v85, v85, 0x3e0293ee, v248
    v_exp_f32 v82, v82
    v_fmamk_f32 v86, v86, 0x3e0293ee, v248
    v_exp_f32 v83, v83
    v_fmamk_f32 v87, v87, 0x3e0293ee, v248
    v_exp_f32 v84, v84
    v_cvt_pk_bf16_f32 v80, v80, v81
    v_exp_f32 v85, v85
    v_exp_f32 v86, v86
    v_cvt_pk_bf16_f32 v81, v82, v83
    v_exp_f32 v87, v87
    v_cvt_pk_bf16_f32 v82, v84, v85
    v_cvt_pk_bf16_f32 v83, v86, v87
    v_fmamk_f32 v88, v88, 0x3e0293ee, v248
    v_fmamk_f32 v89, v89, 0x3e0293ee, v248
    v_fmamk_f32 v90, v90, 0x3e0293ee, v248
    v_fmamk_f32 v91, v91, 0x3e0293ee, v248
    v_exp_f32 v88, v88
    v_fmamk_f32 v92, v92, 0x3e0293ee, v248
    v_exp_f32 v89, v89
    v_fmamk_f32 v93, v93, 0x3e0293ee, v248
    v_exp_f32 v90, v90
    v_fmamk_f32 v94, v94, 0x3e0293ee, v248
    v_exp_f32 v91, v91
    v_fmamk_f32 v95, v95, 0x3e0293ee, v248
    v_exp_f32 v92, v92
    v_cvt_pk_bf16_f32 v84, v88, v89
    v_exp_f32 v93, v93
    v_exp_f32 v94, v94
    v_cvt_pk_bf16_f32 v85, v90, v91
    v_exp_f32 v95, v95
    v_cvt_pk_bf16_f32 v86, v92, v93
    v_cvt_pk_bf16_f32 v87, v94, v95
    v_fmamk_f32 v96, v96, 0x3e0293ee, v248
    v_fmamk_f32 v97, v97, 0x3e0293ee, v248
    v_fmamk_f32 v98, v98, 0x3e0293ee, v248
    v_fmamk_f32 v99, v99, 0x3e0293ee, v248
    v_exp_f32 v96, v96
    v_fmamk_f32 v100, v100, 0x3e0293ee, v248
    v_exp_f32 v97, v97
    v_fmamk_f32 v101, v101, 0x3e0293ee, v248
    v_exp_f32 v98, v98
    v_fmamk_f32 v102, v102, 0x3e0293ee, v248
    v_exp_f32 v99, v99
    v_fmamk_f32 v103, v103, 0x3e0293ee, v248
    v_exp_f32 v100, v100
    v_cvt_pk_bf16_f32 v96, v96, v97
    v_exp_f32 v101, v101
    v_exp_f32 v102, v102
    v_cvt_pk_bf16_f32 v97, v98, v99
    v_exp_f32 v103, v103
    v_cvt_pk_bf16_f32 v98, v100, v101
    v_cvt_pk_bf16_f32 v99, v102, v103
    v_fmamk_f32 v104, v104, 0x3e0293ee, v248
    v_fmamk_f32 v105, v105, 0x3e0293ee, v248
    v_fmamk_f32 v106, v106, 0x3e0293ee, v248
    v_fmamk_f32 v107, v107, 0x3e0293ee, v248
    v_exp_f32 v104, v104
    v_fmamk_f32 v108, v108, 0x3e0293ee, v248
    v_exp_f32 v105, v105
    v_fmamk_f32 v109, v109, 0x3e0293ee, v248
    v_exp_f32 v106, v106
    v_fmamk_f32 v110, v110, 0x3e0293ee, v248
    v_exp_f32 v107, v107
    v_fmamk_f32 v111, v111, 0x3e0293ee, v248
    v_exp_f32 v108, v108
    v_cvt_pk_bf16_f32 v100, v104, v105
    v_exp_f32 v109, v109
    v_exp_f32 v110, v110
    v_cvt_pk_bf16_f32 v101, v106, v107
    v_exp_f32 v111, v111
    v_cvt_pk_bf16_f32 v102, v108, v109
    v_cvt_pk_bf16_f32 v103, v110, v111
    v_fmamk_f32 v112, v112, 0x3e0293ee, v248
    v_fmamk_f32 v113, v113, 0x3e0293ee, v248
    v_fmamk_f32 v114, v114, 0x3e0293ee, v248
    v_fmamk_f32 v115, v115, 0x3e0293ee, v248
    v_exp_f32 v112, v112
    v_fmamk_f32 v116, v116, 0x3e0293ee, v248
    v_exp_f32 v113, v113
    v_fmamk_f32 v117, v117, 0x3e0293ee, v248
    v_exp_f32 v114, v114
    v_fmamk_f32 v118, v118, 0x3e0293ee, v248
    v_exp_f32 v115, v115
    v_fmamk_f32 v119, v119, 0x3e0293ee, v248
    v_exp_f32 v116, v116
    v_cvt_pk_bf16_f32 v112, v112, v113
    v_exp_f32 v117, v117
    v_exp_f32 v118, v118
    v_cvt_pk_bf16_f32 v113, v114, v115
    v_exp_f32 v119, v119
    v_cvt_pk_bf16_f32 v114, v116, v117
    v_cvt_pk_bf16_f32 v115, v118, v119
    v_fmamk_f32 v120, v120, 0x3e0293ee, v248
    v_fmamk_f32 v121, v121, 0x3e0293ee, v248
    v_fmamk_f32 v122, v122, 0x3e0293ee, v248
    v_fmamk_f32 v123, v123, 0x3e0293ee, v248
    v_exp_f32 v120, v120
    v_fmamk_f32 v124, v124, 0x3e0293ee, v248
    v_exp_f32 v121, v121
    v_fmamk_f32 v125, v125, 0x3e0293ee, v248
    v_exp_f32 v122, v122
    v_fmamk_f32 v126, v126, 0x3e0293ee, v248
    v_exp_f32 v123, v123
    v_fmamk_f32 v127, v127, 0x3e0293ee, v248
    v_exp_f32 v124, v124
    v_cvt_pk_bf16_f32 v116, v120, v121
    v_exp_f32 v125, v125
    v_exp_f32 v126, v126
    v_cvt_pk_bf16_f32 v117, v122, v123
    v_exp_f32 v127, v127
    v_cvt_pk_bf16_f32 v118, v124, v125
    v_cvt_pk_bf16_f32 v119, v126, v127
    v_fmamk_f32 v128, v128, 0x3e0293ee, v248
    v_fmamk_f32 v129, v129, 0x3e0293ee, v248
    v_fmamk_f32 v130, v130, 0x3e0293ee, v248
    v_fmamk_f32 v131, v131, 0x3e0293ee, v248
    v_exp_f32 v128, v128
    v_fmamk_f32 v132, v132, 0x3e0293ee, v248
    v_exp_f32 v129, v129
    v_fmamk_f32 v133, v133, 0x3e0293ee, v248
    v_exp_f32 v130, v130
    v_fmamk_f32 v134, v134, 0x3e0293ee, v248
    v_exp_f32 v131, v131
    v_fmamk_f32 v135, v135, 0x3e0293ee, v248
    v_exp_f32 v132, v132
    v_cvt_pk_bf16_f32 v128, v128, v129
    v_exp_f32 v133, v133
    v_exp_f32 v134, v134
    v_cvt_pk_bf16_f32 v129, v130, v131
    v_exp_f32 v135, v135
    v_cvt_pk_bf16_f32 v130, v132, v133
    v_cvt_pk_bf16_f32 v131, v134, v135
    v_fmamk_f32 v136, v136, 0x3e0293ee, v248
    v_fmamk_f32 v137, v137, 0x3e0293ee, v248
    v_fmamk_f32 v138, v138, 0x3e0293ee, v248
    v_fmamk_f32 v139, v139, 0x3e0293ee, v248
    v_exp_f32 v136, v136
    v_fmamk_f32 v140, v140, 0x3e0293ee, v248
    v_exp_f32 v137, v137
    v_fmamk_f32 v141, v141, 0x3e0293ee, v248
    v_exp_f32 v138, v138
    v_fmamk_f32 v142, v142, 0x3e0293ee, v248
    v_exp_f32 v139, v139
    v_fmamk_f32 v143, v143, 0x3e0293ee, v248
    v_exp_f32 v140, v140
    v_cvt_pk_bf16_f32 v132, v136, v137
    v_exp_f32 v141, v141
    v_exp_f32 v142, v142
    v_cvt_pk_bf16_f32 v133, v138, v139
    v_exp_f32 v143, v143
    v_cvt_pk_bf16_f32 v134, v140, v141
    v_cvt_pk_bf16_f32 v135, v142, v143
    v_fmamk_f32 v144, v144, 0x3e0293ee, v248
    v_fmamk_f32 v145, v145, 0x3e0293ee, v248
    v_fmamk_f32 v146, v146, 0x3e0293ee, v248
    v_fmamk_f32 v147, v147, 0x3e0293ee, v248
    v_exp_f32 v144, v144
    v_fmamk_f32 v148, v148, 0x3e0293ee, v248
    v_exp_f32 v145, v145
    v_fmamk_f32 v149, v149, 0x3e0293ee, v248
    v_exp_f32 v146, v146
    v_fmamk_f32 v150, v150, 0x3e0293ee, v248
    v_exp_f32 v147, v147
    v_fmamk_f32 v151, v151, 0x3e0293ee, v248
    v_exp_f32 v148, v148
    v_cvt_pk_bf16_f32 v144, v144, v145
    v_exp_f32 v149, v149
    v_exp_f32 v150, v150
    v_cvt_pk_bf16_f32 v145, v146, v147
    v_exp_f32 v151, v151
    v_cvt_pk_bf16_f32 v146, v148, v149
    v_cvt_pk_bf16_f32 v147, v150, v151
    v_fmamk_f32 v152, v152, 0x3e0293ee, v248
    v_fmamk_f32 v153, v153, 0x3e0293ee, v248
    v_fmamk_f32 v154, v154, 0x3e0293ee, v248
    v_fmamk_f32 v155, v155, 0x3e0293ee, v248
    v_exp_f32 v152, v152
    v_fmamk_f32 v156, v156, 0x3e0293ee, v248
    v_exp_f32 v153, v153
    v_fmamk_f32 v157, v157, 0x3e0293ee, v248
    v_exp_f32 v154, v154
    v_fmamk_f32 v158, v158, 0x3e0293ee, v248
    v_exp_f32 v155, v155
    v_fmamk_f32 v159, v159, 0x3e0293ee, v248
    v_exp_f32 v156, v156
    v_cvt_pk_bf16_f32 v148, v152, v153
    v_exp_f32 v157, v157
    v_exp_f32 v158, v158
    v_cvt_pk_bf16_f32 v149, v154, v155
    v_exp_f32 v159, v159
    v_cvt_pk_bf16_f32 v150, v156, v157
    v_cvt_pk_bf16_f32 v151, v158, v159
    s_waitcnt vmcnt(0)
    s_cmp_ge_u32 s18, 4
    s_cbranch_scc1 L_nobar
    s_barrier
L_nobar:
    v_add_u32 v240, 0x10000, v244
    v_add_u32 v241, 0x10000, v245
    v_add_u32 v242, 0x10000, v246
    v_add_u32 v243, 0x10000, v247
    ds_read_b64_tr_b16 v[224:225], v244 offset:0
    ds_read_b64_tr_b16 v[226:227], v244 offset:2048
    ds_read_b64_tr_b16 v[228:229], v244 offset:4096
    ds_read_b64_tr_b16 v[230:231], v244 offset:6144
    ds_read_b64_tr_b16 v[232:233], v244 offset:8192
    ds_read_b64_tr_b16 v[234:235], v244 offset:10240
    ds_read_b64_tr_b16 v[236:237], v244 offset:12288
    ds_read_b64_tr_b16 v[238:239], v244 offset:14336
    s_cmp_ge_u32 s18, 4
    s_cbranch_scc1 L_noq16
    s_add_u32 s44, s38, 64
    v_and_b32 v252, 15, v251
    v_add_u32 v252, s44, v252
    v_lshrrev_b32 v254, 4, v251
    v_lshlrev_b32 v254, 4, v254
    v_lshl_add_u32 v254, v252, 8, v254
    buffer_load_dwordx4 v[8:11], v254, s[20:23], 0 offen offset:0
    buffer_load_dwordx4 v[12:15], v254, s[20:23], 0 offen offset:64
    buffer_load_dwordx4 v[24:27], v254, s[20:23], 0 offen offset:128
    buffer_load_dwordx4 v[28:31], v254, s[20:23], 0 offen offset:192
L_noq16:
    s_waitcnt lgkmcnt(6)
    v_mfma_f32_32x32x16_bf16 v[160:175], v[224:227], v[0:3], 0
    ds_read_b64_tr_b16 v[224:225], v244 offset:16384
    ds_read_b64_tr_b16 v[226:227], v244 offset:18432
    s_waitcnt lgkmcnt(6)
    v_mfma_f32_32x32x16_bf16 v[160:175], v[228:231], v[4:7], v[160:175]
    ds_read_b64_tr_b16 v[228:229], v244 offset:20480
    ds_read_b64_tr_b16 v[230:231], v244 offset:22528
    v_smfmac_f32_16x16x64_bf16 v[44:47], v[40:43], v[0:7], v56
    v_and_b32 v252, 15, v251
    v_add_u32 v252, s38, v252
    s_waitcnt lgkmcnt(6)
    v_mfma_f32_32x32x16_bf16 v[160:175], v[232:235], v[16:19], v[160:175]
    ds_read_b64_tr_b16 v[232:233], v244 offset:24576
    ds_read_b64_tr_b16 v[234:235], v244 offset:26624
    v_bfrev_b32 v250, v251
    v_bfe_u32 v250, v250, 26, 2
    s_waitcnt lgkmcnt(6)
    v_mfma_f32_32x32x16_bf16 v[160:175], v[236:239], v[20:23], v[160:175]
    ds_read_b64_tr_b16 v[236:237], v244 offset:28672
    ds_read_b64_tr_b16 v[238:239], v244 offset:30720
    v_smfmac_f32_16x16x64_bf16 v[44:47], v[40:43], v[16:23], v56
    v_lshlrev_b32 v250, 4, v250
    v_lshl_or_b32 v250, v252, 8, v250
    s_waitcnt lgkmcnt(6)
    v_mfma_f32_32x32x16_bf16 v[160:175], v[224:227], v[32:35], v[160:175]
    ds_read_b64_tr_b16 v[224:225], v244 offset:32768
    ds_read_b64_tr_b16 v[226:227], v244 offset:34816
    s_movk_i32 s50, 0x1000
    s_movk_i32 s51, 0x4000
    s_waitcnt lgkmcnt(6)
    v_mfma_f32_32x32x16_bf16 v[160:175], v[228:231], v[36:39], v[160:175]
    ds_read_b64_tr_b16 v[228:229], v244 offset:36864
    ds_read_b64_tr_b16 v[230:231], v244 offset:38912
    v_smfmac_f32_16x16x64_bf16 v[44:47], v[40:43], v[32:39], v56
    s_waitcnt lgkmcnt(6)
    v_mfma_f32_32x32x16_bf16 v[160:175], v[232:235], v[48:51], v[160:175]
    ds_read_b64_tr_b16 v[232:233], v244 offset:40960
    ds_read_b64_tr_b16 v[234:235], v244 offset:43008
    s_waitcnt lgkmcnt(6)
    v_mfma_f32_32x32x16_bf16 v[160:175], v[236:239], v[52:55], v[160:175]
    ds_read_b64_tr_b16 v[236:237], v244 offset:45056
    ds_read_b64_tr_b16 v[238:239], v244 offset:47104
    v_smfmac_f32_16x16x64_bf16 v[44:47], v[40:43], v[48:55], v56
    s_waitcnt lgkmcnt(6)
    v_mfma_f32_32x32x16_bf16 v[160:175], v[224:227], v[64:67], v[160:175]
    ds_read_b64_tr_b16 v[224:225], v244 offset:49152
    ds_read_b64_tr_b16 v[226:227], v244 offset:51200
    s_waitcnt lgkmcnt(6)
    v_mfma_f32_32x32x16_bf16 v[160:175], v[228:231], v[68:71], v[160:175]
    ds_read_b64_tr_b16 v[228:229], v244 offset:53248
    ds_read_b64_tr_b16 v[230:231], v244 offset:55296
    v_smfmac_f32_16x16x64_bf16 v[44:47], v[40:43], v[64:71], v56
    s_waitcnt lgkmcnt(6)
    v_mfma_f32_32x32x16_bf16 v[160:175], v[232:235], v[80:83], v[160:175]
    ds_read_b64_tr_b16 v[232:233], v244 offset:57344
    ds_read_b64_tr_b16 v[234:235], v244 offset:59392
    s_waitcnt lgkmcnt(6)
    v_mfma_f32_32x32x16_bf16 v[160:175], v[236:239], v[84:87], v[160:175]
    ds_read_b64_tr_b16 v[236:237], v244 offset:61440
    ds_read_b64_tr_b16 v[238:239], v244 offset:63488
    v_smfmac_f32_16x16x64_bf16 v[44:47], v[40:43], v[80:87], v56
    s_waitcnt lgkmcnt(6)
    v_mfma_f32_32x32x16_bf16 v[160:175], v[224:227], v[96:99], v[160:175]
    ds_read_b64_tr_b16 v[224:225], v240 offset:0
    ds_read_b64_tr_b16 v[226:227], v240 offset:2048
    s_waitcnt lgkmcnt(6)
    v_mfma_f32_32x32x16_bf16 v[160:175], v[228:231], v[100:103], v[160:175]
    ds_read_b64_tr_b16 v[228:229], v240 offset:4096
    ds_read_b64_tr_b16 v[230:231], v240 offset:6144
    v_smfmac_f32_16x16x64_bf16 v[44:47], v[40:43], v[96:103], v56
    s_waitcnt lgkmcnt(6)
    v_mfma_f32_32x32x16_bf16 v[160:175], v[232:235], v[112:115], v[160:175]
    ds_read_b64_tr_b16 v[232:233], v240 offset:8192
    ds_read_b64_tr_b16 v[234:235], v240 offset:10240
    s_waitcnt lgkmcnt(6)
    v_mfma_f32_32x32x16_bf16 v[160:175], v[236:239], v[116:119], v[160:175]
    ds_read_b64_tr_b16 v[236:237], v240 offset:12288
    ds_read_b64_tr_b16 v[238:239], v240 offset:14336
    v_smfmac_f32_16x16x64_bf16 v[44:47], v[40:43], v[112:119], v56
    s_waitcnt lgkmcnt(6)
    v_mfma_f32_32x32x16_bf16 v[160:175], v[224:227], v[128:131], v[160:175]
    ds_read_b64_tr_b16 v[224:225], v245 offset:0
    ds_read_b64_tr_b16 v[226:227], v245 offset:2048
    s_waitcnt lgkmcnt(6)
    v_mfma_f32_32x32x16_bf16 v[160:175], v[228:231], v[132:135], v[160:175]
    ds_read_b64_tr_b16 v[228:229], v245 offset:4096
    ds_read_b64_tr_b16 v[230:231], v245 offset:6144
    v_smfmac_f32_16x16x64_bf16 v[44:47], v[40:43], v[128:135], v56
    s_waitcnt lgkmcnt(6)
    v_mfma_f32_32x32x16_bf16 v[160:175], v[232:235], v[144:147], v[160:175]
    ds_read_b64_tr_b16 v[232:233], v245 offset:8192
    ds_read_b64_tr_b16 v[234:235], v245 offset:10240
    s_waitcnt lgkmcnt(6)
    v_mfma_f32_32x32x16_bf16 v[160:175], v[236:239], v[148:151], v[160:175]
    ds_read_b64_tr_b16 v[236:237], v245 offset:12288
    ds_read_b64_tr_b16 v[238:239], v245 offset:14336
    v_smfmac_f32_16x16x64_bf16 v[44:47], v[40:43], v[144:151], v56
    s_waitcnt lgkmcnt(6)
    v_mfma_f32_32x32x16_bf16 v[176:191], v[224:227], v[0:3], 0
    ds_read_b64_tr_b16 v[224:225], v245 offset:16384
    ds_read_b64_tr_b16 v[226:227], v245 offset:18432
    s_waitcnt lgkmcnt(6)
    v_mfma_f32_32x32x16_bf16 v[176:191], v[228:231], v[4:7], v[176:191]
    ds_read_b64_tr_b16 v[228:229], v245 offset:20480
    ds_read_b64_tr_b16 v[230:231], v245 offset:22528
    s_waitcnt lgkmcnt(6)
    v_mfma_f32_32x32x16_bf16 v[176:191], v[232:235], v[16:19], v[176:191]
    ds_read_b64_tr_b16 v[232:233], v245 offset:24576
    ds_read_b64_tr_b16 v[234:235], v245 offset:26624
    v_add_f32 v44, v44, v45
    v_rcp_f32 v249, v44
    s_waitcnt lgkmcnt(6)
    v_mfma_f32_32x32x16_bf16 v[176:191], v[236:239], v[20:23], v[176:191]
    ds_read_b64_tr_b16 v[236:237], v245 offset:28672
    ds_read_b64_tr_b16 v[238:239], v245 offset:30720
    v_mul_f32 v160, v160, v249
    v_mul_f32 v161, v161, v249
    s_waitcnt lgkmcnt(6)
    v_mfma_f32_32x32x16_bf16 v[176:191], v[224:227], v[32:35], v[176:191]
    ds_read_b64_tr_b16 v[224:225], v245 offset:32768
    ds_read_b64_tr_b16 v[226:227], v245 offset:34816
    v_mul_f32 v162, v162, v249
    v_mul_f32 v163, v163, v249
    s_waitcnt lgkmcnt(6)
    v_mfma_f32_32x32x16_bf16 v[176:191], v[228:231], v[36:39], v[176:191]
    ds_read_b64_tr_b16 v[228:229], v245 offset:36864
    ds_read_b64_tr_b16 v[230:231], v245 offset:38912
    v_mul_f32 v164, v164, v249
    v_mul_f32 v165, v165, v249
    s_waitcnt lgkmcnt(6)
    v_mfma_f32_32x32x16_bf16 v[176:191], v[232:235], v[48:51], v[176:191]
    ds_read_b64_tr_b16 v[232:233], v245 offset:40960
    ds_read_b64_tr_b16 v[234:235], v245 offset:43008
    v_mul_f32 v166, v166, v249
    v_mul_f32 v167, v167, v249
    s_waitcnt lgkmcnt(6)
    v_mfma_f32_32x32x16_bf16 v[176:191], v[236:239], v[52:55], v[176:191]
    ds_read_b64_tr_b16 v[236:237], v245 offset:45056
    ds_read_b64_tr_b16 v[238:239], v245 offset:47104
    v_mul_f32 v168, v168, v249
    v_mul_f32 v169, v169, v249
    s_waitcnt lgkmcnt(6)
    v_mfma_f32_32x32x16_bf16 v[176:191], v[224:227], v[64:67], v[176:191]
    ds_read_b64_tr_b16 v[224:225], v245 offset:49152
    ds_read_b64_tr_b16 v[226:227], v245 offset:51200
    v_mul_f32 v170, v170, v249
    v_mul_f32 v171, v171, v249
    s_waitcnt lgkmcnt(6)
    v_mfma_f32_32x32x16_bf16 v[176:191], v[228:231], v[68:71], v[176:191]
    ds_read_b64_tr_b16 v[228:229], v245 offset:53248
    ds_read_b64_tr_b16 v[230:231], v245 offset:55296
    v_mul_f32 v172, v172, v249
    v_mul_f32 v173, v173, v249
    s_waitcnt lgkmcnt(6)
    v_mfma_f32_32x32x16_bf16 v[176:191], v[232:235], v[80:83], v[176:191]
    ds_read_b64_tr_b16 v[232:233], v245 offset:57344
    ds_read_b64_tr_b16 v[234:235], v245 offset:59392
    v_mul_f32 v174, v174, v249
    v_mul_f32 v175, v175, v249
    s_waitcnt lgkmcnt(6)
    v_mfma_f32_32x32x16_bf16 v[176:191], v[236:239], v[84:87], v[176:191]
    ds_read_b64_tr_b16 v[236:237], v245 offset:61440
    ds_read_b64_tr_b16 v[238:239], v245 offset:63488
    v_cvt_pk_bf16_f32 v160, v160, v161
    v_cvt_pk_bf16_f32 v161, v162, v163
    s_waitcnt lgkmcnt(6)
    v_mfma_f32_32x32x16_bf16 v[176:191], v[224:227], v[96:99], v[176:191]
    ds_read_b64_tr_b16 v[224:225], v241 offset:0
    ds_read_b64_tr_b16 v[226:227], v241 offset:2048
    v_cvt_pk_bf16_f32 v162, v164, v165
    v_cvt_pk_bf16_f32 v163, v166, v167
    s_waitcnt lgkmcnt(6)
    v_mfma_f32_32x32x16_bf16 v[176:191], v[228:231], v[100:103], v[176:191]
    ds_read_b64_tr_b16 v[228:229], v241 offset:4096
    ds_read_b64_tr_b16 v[230:231], v241 offset:6144
    v_cvt_pk_bf16_f32 v164, v168, v169
    v_cvt_pk_bf16_f32 v165, v170, v171
    s_waitcnt lgkmcnt(6)
    v_mfma_f32_32x32x16_bf16 v[176:191], v[232:235], v[112:115], v[176:191]
    ds_read_b64_tr_b16 v[232:233], v241 offset:8192
    ds_read_b64_tr_b16 v[234:235], v241 offset:10240
    v_cvt_pk_bf16_f32 v166, v172, v173
    v_cvt_pk_bf16_f32 v167, v174, v175
    s_waitcnt lgkmcnt(6)
    v_mfma_f32_32x32x16_bf16 v[176:191], v[236:239], v[116:119], v[176:191]
    ds_read_b64_tr_b16 v[236:237], v241 offset:12288
    ds_read_b64_tr_b16 v[238:239], v241 offset:14336
    v_permlane16_swap_b32 v160, v164
    v_permlane16_swap_b32 v161, v165
    s_waitcnt lgkmcnt(6)
    v_mfma_f32_32x32x16_bf16 v[176:191], v[224:227], v[128:131], v[176:191]
    ds_read_b64_tr_b16 v[224:225], v246 offset:0
    ds_read_b64_tr_b16 v[226:227], v246 offset:2048
    v_permlane16_swap_b32 v162, v166
    v_permlane16_swap_b32 v163, v167
    s_waitcnt lgkmcnt(6)
    v_mfma_f32_32x32x16_bf16 v[176:191], v[228:231], v[132:135], v[176:191]
    ds_read_b64_tr_b16 v[228:229], v246 offset:4096
    ds_read_b64_tr_b16 v[230:231], v246 offset:6144
    buffer_store_dwordx4 v[160:163], v250, s[32:35], 0 offen offset:0 sc1
    buffer_store_dwordx4 v[164:167], v250, s[32:35], s50 offen offset:0 sc1
    s_waitcnt lgkmcnt(6)
    v_mfma_f32_32x32x16_bf16 v[176:191], v[232:235], v[144:147], v[176:191]
    ds_read_b64_tr_b16 v[232:233], v246 offset:8192
    ds_read_b64_tr_b16 v[234:235], v246 offset:10240
    s_waitcnt lgkmcnt(6)
    v_mfma_f32_32x32x16_bf16 v[176:191], v[236:239], v[148:151], v[176:191]
    ds_read_b64_tr_b16 v[236:237], v246 offset:12288
    ds_read_b64_tr_b16 v[238:239], v246 offset:14336
    s_waitcnt lgkmcnt(6)
    v_mfma_f32_32x32x16_bf16 v[192:207], v[224:227], v[0:3], 0
    ds_read_b64_tr_b16 v[224:225], v246 offset:16384
    ds_read_b64_tr_b16 v[226:227], v246 offset:18432
    s_waitcnt lgkmcnt(6)
    v_mfma_f32_32x32x16_bf16 v[192:207], v[228:231], v[4:7], v[192:207]
    ds_read_b64_tr_b16 v[228:229], v246 offset:20480
    ds_read_b64_tr_b16 v[230:231], v246 offset:22528
    s_waitcnt lgkmcnt(6)
    v_mfma_f32_32x32x16_bf16 v[192:207], v[232:235], v[16:19], v[192:207]
    ds_read_b64_tr_b16 v[232:233], v246 offset:24576
    ds_read_b64_tr_b16 v[234:235], v246 offset:26624
    v_mul_f32 v176, v176, v249
    v_mul_f32 v177, v177, v249
    s_waitcnt lgkmcnt(6)
    v_mfma_f32_32x32x16_bf16 v[192:207], v[236:239], v[20:23], v[192:207]
    ds_read_b64_tr_b16 v[236:237], v246 offset:28672
    ds_read_b64_tr_b16 v[238:239], v246 offset:30720
    v_mul_f32 v178, v178, v249
    v_mul_f32 v179, v179, v249
    s_waitcnt lgkmcnt(6)
    v_mfma_f32_32x32x16_bf16 v[192:207], v[224:227], v[32:35], v[192:207]
    ds_read_b64_tr_b16 v[224:225], v246 offset:32768
    ds_read_b64_tr_b16 v[226:227], v246 offset:34816
    v_mul_f32 v180, v180, v249
    v_mul_f32 v181, v181, v249
    s_waitcnt lgkmcnt(6)
    v_mfma_f32_32x32x16_bf16 v[192:207], v[228:231], v[36:39], v[192:207]
    ds_read_b64_tr_b16 v[228:229], v246 offset:36864
    ds_read_b64_tr_b16 v[230:231], v246 offset:38912
    v_mul_f32 v182, v182, v249
    v_mul_f32 v183, v183, v249
    s_waitcnt lgkmcnt(6)
    v_mfma_f32_32x32x16_bf16 v[192:207], v[232:235], v[48:51], v[192:207]
    ds_read_b64_tr_b16 v[232:233], v246 offset:40960
    ds_read_b64_tr_b16 v[234:235], v246 offset:43008
    v_mul_f32 v184, v184, v249
    v_mul_f32 v185, v185, v249
    s_waitcnt lgkmcnt(6)
    v_mfma_f32_32x32x16_bf16 v[192:207], v[236:239], v[52:55], v[192:207]
    ds_read_b64_tr_b16 v[236:237], v246 offset:45056
    ds_read_b64_tr_b16 v[238:239], v246 offset:47104
    v_mul_f32 v186, v186, v249
    v_mul_f32 v187, v187, v249
    s_waitcnt lgkmcnt(6)
    v_mfma_f32_32x32x16_bf16 v[192:207], v[224:227], v[64:67], v[192:207]
    ds_read_b64_tr_b16 v[224:225], v246 offset:49152
    ds_read_b64_tr_b16 v[226:227], v246 offset:51200
    v_mul_f32 v188, v188, v249
    v_mul_f32 v189, v189, v249
    s_waitcnt lgkmcnt(6)
    v_mfma_f32_32x32x16_bf16 v[192:207], v[228:231], v[68:71], v[192:207]
    ds_read_b64_tr_b16 v[228:229], v246 offset:53248
    ds_read_b64_tr_b16 v[230:231], v246 offset:55296
    v_mul_f32 v190, v190, v249
    v_mul_f32 v191, v191, v249
    s_waitcnt lgkmcnt(6)
    v_mfma_f32_32x32x16_bf16 v[192:207], v[232:235], v[80:83], v[192:207]
    ds_read_b64_tr_b16 v[232:233], v246 offset:57344
    ds_read_b64_tr_b16 v[234:235], v246 offset:59392
    v_cvt_pk_bf16_f32 v176, v176, v177
    v_cvt_pk_bf16_f32 v177, v178, v179
    s_waitcnt lgkmcnt(6)
    v_mfma_f32_32x32x16_bf16 v[192:207], v[236:239], v[84:87], v[192:207]
    ds_read_b64_tr_b16 v[236:237], v246 offset:61440
    ds_read_b64_tr_b16 v[238:239], v246 offset:63488
    v_cvt_pk_bf16_f32 v178, v180, v181
    v_cvt_pk_bf16_f32 v179, v182, v183
    s_waitcnt lgkmcnt(6)
    v_mfma_f32_32x32x16_bf16 v[192:207], v[224:227], v[96:99], v[192:207]
    ds_read_b64_tr_b16 v[224:225], v242 offset:0
    ds_read_b64_tr_b16 v[226:227], v242 offset:2048
    v_cvt_pk_bf16_f32 v180, v184, v185
    v_cvt_pk_bf16_f32 v181, v186, v187
    s_waitcnt lgkmcnt(6)
    v_mfma_f32_32x32x16_bf16 v[192:207], v[228:231], v[100:103], v[192:207]
    ds_read_b64_tr_b16 v[228:229], v242 offset:4096
    ds_read_b64_tr_b16 v[230:231], v242 offset:6144
    v_cvt_pk_bf16_f32 v182, v188, v189
    v_cvt_pk_bf16_f32 v183, v190, v191
    s_waitcnt lgkmcnt(6)
    v_mfma_f32_32x32x16_bf16 v[192:207], v[232:235], v[112:115], v[192:207]
    ds_read_b64_tr_b16 v[232:233], v242 offset:8192
    ds_read_b64_tr_b16 v[234:235], v242 offset:10240
    v_permlane16_swap_b32 v176, v180
    v_permlane16_swap_b32 v177, v181
    s_waitcnt lgkmcnt(6)
    v_mfma_f32_32x32x16_bf16 v[192:207], v[236:239], v[116:119], v[192:207]
    ds_read_b64_tr_b16 v[236:237], v242 offset:12288
    ds_read_b64_tr_b16 v[238:239], v242 offset:14336
    v_permlane16_swap_b32 v178, v182
    v_permlane16_swap_b32 v179, v183
    s_waitcnt lgkmcnt(6)
    v_mfma_f32_32x32x16_bf16 v[192:207], v[224:227], v[128:131], v[192:207]
    ds_read_b64_tr_b16 v[224:225], v247 offset:0
    ds_read_b64_tr_b16 v[226:227], v247 offset:2048
    buffer_store_dwordx4 v[176:179], v250, s[32:35], 0 offen offset:64 sc1
    buffer_store_dwordx4 v[180:183], v250, s[32:35], s50 offen offset:64 sc1
    s_waitcnt lgkmcnt(6)
    v_mfma_f32_32x32x16_bf16 v[192:207], v[228:231], v[132:135], v[192:207]
    ds_read_b64_tr_b16 v[228:229], v247 offset:4096
    ds_read_b64_tr_b16 v[230:231], v247 offset:6144
    s_waitcnt lgkmcnt(6)
    v_mfma_f32_32x32x16_bf16 v[192:207], v[232:235], v[144:147], v[192:207]
    ds_read_b64_tr_b16 v[232:233], v247 offset:8192
    ds_read_b64_tr_b16 v[234:235], v247 offset:10240
    s_waitcnt lgkmcnt(6)
    v_mfma_f32_32x32x16_bf16 v[192:207], v[236:239], v[148:151], v[192:207]
    ds_read_b64_tr_b16 v[236:237], v247 offset:12288
    ds_read_b64_tr_b16 v[238:239], v247 offset:14336
    s_waitcnt lgkmcnt(6)
    v_mfma_f32_32x32x16_bf16 v[208:223], v[224:227], v[0:3], 0
    ds_read_b64_tr_b16 v[224:225], v247 offset:16384
    ds_read_b64_tr_b16 v[226:227], v247 offset:18432
    s_waitcnt lgkmcnt(6)
    v_mfma_f32_32x32x16_bf16 v[208:223], v[228:231], v[4:7], v[208:223]
    ds_read_b64_tr_b16 v[228:229], v247 offset:20480
    ds_read_b64_tr_b16 v[230:231], v247 offset:22528
    s_waitcnt lgkmcnt(6)
    v_mfma_f32_32x32x16_bf16 v[208:223], v[232:235], v[16:19], v[208:223]
    ds_read_b64_tr_b16 v[232:233], v247 offset:24576
    ds_read_b64_tr_b16 v[234:235], v247 offset:26624
    v_mul_f32 v192, v192, v249
    v_mul_f32 v193, v193, v249
    s_waitcnt lgkmcnt(6)
    v_mfma_f32_32x32x16_bf16 v[208:223], v[236:239], v[20:23], v[208:223]
    ds_read_b64_tr_b16 v[236:237], v247 offset:28672
    ds_read_b64_tr_b16 v[238:239], v247 offset:30720
    v_mul_f32 v194, v194, v249
    v_mul_f32 v195, v195, v249
    s_waitcnt lgkmcnt(6)
    v_mfma_f32_32x32x16_bf16 v[208:223], v[224:227], v[32:35], v[208:223]
    ds_read_b64_tr_b16 v[224:225], v247 offset:32768
    ds_read_b64_tr_b16 v[226:227], v247 offset:34816
    v_mul_f32 v196, v196, v249
    v_mul_f32 v197, v197, v249
    s_waitcnt lgkmcnt(6)
    v_mfma_f32_32x32x16_bf16 v[208:223], v[228:231], v[36:39], v[208:223]
    ds_read_b64_tr_b16 v[228:229], v247 offset:36864
    ds_read_b64_tr_b16 v[230:231], v247 offset:38912
    v_mul_f32 v198, v198, v249
    v_mul_f32 v199, v199, v249
    s_waitcnt lgkmcnt(6)
    v_mfma_f32_32x32x16_bf16 v[208:223], v[232:235], v[48:51], v[208:223]
    ds_read_b64_tr_b16 v[232:233], v247 offset:40960
    ds_read_b64_tr_b16 v[234:235], v247 offset:43008
    v_mul_f32 v200, v200, v249
    v_mul_f32 v201, v201, v249
    s_waitcnt lgkmcnt(6)
    v_mfma_f32_32x32x16_bf16 v[208:223], v[236:239], v[52:55], v[208:223]
    ds_read_b64_tr_b16 v[236:237], v247 offset:45056
    ds_read_b64_tr_b16 v[238:239], v247 offset:47104
    v_mul_f32 v202, v202, v249
    v_mul_f32 v203, v203, v249
    s_waitcnt lgkmcnt(6)
    v_mfma_f32_32x32x16_bf16 v[208:223], v[224:227], v[64:67], v[208:223]
    ds_read_b64_tr_b16 v[224:225], v247 offset:49152
    ds_read_b64_tr_b16 v[226:227], v247 offset:51200
    v_mul_f32 v204, v204, v249
    v_mul_f32 v205, v205, v249
    s_waitcnt lgkmcnt(6)
    v_mfma_f32_32x32x16_bf16 v[208:223], v[228:231], v[68:71], v[208:223]
    ds_read_b64_tr_b16 v[228:229], v247 offset:53248
    ds_read_b64_tr_b16 v[230:231], v247 offset:55296
    v_mul_f32 v206, v206, v249
    v_mul_f32 v207, v207, v249
    s_waitcnt lgkmcnt(6)
    v_mfma_f32_32x32x16_bf16 v[208:223], v[232:235], v[80:83], v[208:223]
    ds_read_b64_tr_b16 v[232:233], v247 offset:57344
    ds_read_b64_tr_b16 v[234:235], v247 offset:59392
    v_cvt_pk_bf16_f32 v192, v192, v193
    v_cvt_pk_bf16_f32 v193, v194, v195
    s_waitcnt lgkmcnt(6)
    v_mfma_f32_32x32x16_bf16 v[208:223], v[236:239], v[84:87], v[208:223]
    ds_read_b64_tr_b16 v[236:237], v247 offset:61440
    ds_read_b64_tr_b16 v[238:239], v247 offset:63488
    v_cvt_pk_bf16_f32 v194, v196, v197
    v_cvt_pk_bf16_f32 v195, v198, v199
    s_waitcnt lgkmcnt(6)
    v_mfma_f32_32x32x16_bf16 v[208:223], v[224:227], v[96:99], v[208:223]
    ds_read_b64_tr_b16 v[224:225], v243 offset:0
    ds_read_b64_tr_b16 v[226:227], v243 offset:2048
    v_cvt_pk_bf16_f32 v196, v200, v201
    v_cvt_pk_bf16_f32 v197, v202, v203
    s_waitcnt lgkmcnt(6)
    v_mfma_f32_32x32x16_bf16 v[208:223], v[228:231], v[100:103], v[208:223]
    ds_read_b64_tr_b16 v[228:229], v243 offset:4096
    ds_read_b64_tr_b16 v[230:231], v243 offset:6144
    v_cvt_pk_bf16_f32 v198, v204, v205
    v_cvt_pk_bf16_f32 v199, v206, v207
    s_waitcnt lgkmcnt(6)
    v_mfma_f32_32x32x16_bf16 v[208:223], v[232:235], v[112:115], v[208:223]
    ds_read_b64_tr_b16 v[232:233], v243 offset:8192
    ds_read_b64_tr_b16 v[234:235], v243 offset:10240
    v_permlane16_swap_b32 v192, v196
    v_permlane16_swap_b32 v193, v197
    s_waitcnt lgkmcnt(6)
    v_mfma_f32_32x32x16_bf16 v[208:223], v[236:239], v[116:119], v[208:223]
    ds_read_b64_tr_b16 v[236:237], v243 offset:12288
    ds_read_b64_tr_b16 v[238:239], v243 offset:14336
    v_permlane16_swap_b32 v194, v198
    v_permlane16_swap_b32 v195, v199
    s_waitcnt lgkmcnt(6)
    v_mfma_f32_32x32x16_bf16 v[208:223], v[224:227], v[128:131], v[208:223]
    buffer_store_dwordx4 v[192:195], v250, s[32:35], 0 offen offset:128 sc1
    buffer_store_dwordx4 v[196:199], v250, s[32:35], s50 offen offset:128 sc1
    s_waitcnt lgkmcnt(4)
    v_mfma_f32_32x32x16_bf16 v[208:223], v[228:231], v[132:135], v[208:223]
    s_waitcnt lgkmcnt(2)
    v_mfma_f32_32x32x16_bf16 v[208:223], v[232:235], v[144:147], v[208:223]
    s_waitcnt lgkmcnt(0)
    v_mfma_f32_32x32x16_bf16 v[208:223], v[236:239], v[148:151], v[208:223]
    s_nop 11
    v_mul_f32 v208, v208, v249
    v_mul_f32 v209, v209, v249
    v_mul_f32 v210, v210, v249
    v_mul_f32 v211, v211, v249
    v_mul_f32 v212, v212, v249
    v_mul_f32 v213, v213, v249
    v_mul_f32 v214, v214, v249
    v_mul_f32 v215, v215, v249
    v_mul_f32 v216, v216, v249
    v_mul_f32 v217, v217, v249
    v_mul_f32 v218, v218, v249
    v_mul_f32 v219, v219, v249
    v_mul_f32 v220, v220, v249
    v_mul_f32 v221, v221, v249
    v_mul_f32 v222, v222, v249
    v_mul_f32 v223, v223, v249
    v_cvt_pk_bf16_f32 v208, v208, v209
    v_cvt_pk_bf16_f32 v209, v210, v211
    v_cvt_pk_bf16_f32 v210, v212, v213
    v_cvt_pk_bf16_f32 v211, v214, v215
    v_cvt_pk_bf16_f32 v212, v216, v217
    v_cvt_pk_bf16_f32 v213, v218, v219
    v_cvt_pk_bf16_f32 v214, v220, v221
    v_cvt_pk_bf16_f32 v215, v222, v223
    v_permlane16_swap_b32 v208, v212
    v_permlane16_swap_b32 v209, v213
    v_permlane16_swap_b32 v210, v214
    v_permlane16_swap_b32 v211, v215
    buffer_store_dwordx4 v[208:211], v250, s[32:35], 0 offen offset:192 sc1
    buffer_store_dwordx4 v[212:215], v250, s[32:35], s50 offen offset:192 sc1
    s_cmp_ge_u32 s18, 4
    s_cbranch_scc1 L_fin
    v_and_b32 v237, 15, v251
    v_lshrrev_b32 v238, 4, v251
    v_xor_b32 v239, v237, v238
    v_lshlrev_b32 v239, 4, v239
    v_lshl_or_b32 v224, v237, 8, v239
    v_xor_b32 v225, 64, v224
    v_xor_b32 v226, 128, v224
    v_xor_b32 v227, 192, v224
    v_mov_b32 v248, 0xff800000
    ds_read_b128 v[160:163], v224 offset:0
    ds_read_b128 v[164:167], v225 offset:0
    ds_read_b128 v[168:171], v226 offset:0
    ds_read_b128 v[172:175], v227 offset:0
    ds_read_b128 v[176:179], v224 offset:4096
    ds_read_b128 v[180:183], v225 offset:4096
    ds_read_b128 v[184:187], v226 offset:4096
    ds_read_b128 v[188:191], v227 offset:4096
    v_bfe_u32 v239, v251, 2, 2
    v_and_b32 v240, 1, v238
    v_lshl_or_b32 v240, v239, 1, v240
    v_lshlrev_b32 v240, 5, v240
    v_lshl_add_u32 v239, v238, 2, v239
    v_lshl_or_b32 v240, v239, 8, v240
    v_and_b32 v239, 3, v251
    v_lshl_or_b32 v240, v239, 3, v240
    v_add_u32 v228, 81920, v240
    v_xor_b32 v229, 32, v228
    v_xor_b32 v230, 64, v228
    v_xor_b32 v231, 96, v228
    v_xor_b32 v232, 128, v228
    v_xor_b32 v233, 160, v228
    v_xor_b32 v234, 192, v228
    v_xor_b32 v235, 224, v228
    v_add_u32 v237, s44, v237
    v_and_b32 v239, 1, v238
    v_lshlrev_b32 v239, 5, v239
    v_lshrrev_b32 v240, 1, v238
    v_lshl_or_b32 v239, v240, 4, v239
    v_lshl_add_u32 v236, v237, 8, v239
    v_mov_b32 v249, 0
    v_mov_b32 v255, 0
    s_waitcnt vmcnt(8)
    s_waitcnt lgkmcnt(7)
    v_mfma_f32_16x16x32_bf16 v[32:35], v[160:163], v[8:11], 0
    ds_read_b128 v[160:163], v224 offset:8192
    s_waitcnt lgkmcnt(7)
    v_mfma_f32_16x16x32_bf16 v[32:35], v[164:167], v[12:15], v[32:35]
    ds_read_b128 v[164:167], v225 offset:8192
    s_waitcnt lgkmcnt(7)
    v_mfma_f32_16x16x32_bf16 v[32:35], v[168:171], v[24:27], v[32:35]
    ds_read_b128 v[168:171], v226 offset:8192
    s_waitcnt lgkmcnt(7)
    v_mfma_f32_16x16x32_bf16 v[32:35], v[172:175], v[28:31], v[32:35]
    ds_read_b128 v[172:175], v227 offset:8192
    s_waitcnt lgkmcnt(7)
    v_mfma_f32_16x16x32_bf16 v[36:39], v[176:179], v[8:11], 0
    ds_read_b128 v[176:179], v224 offset:12288
    s_waitcnt lgkmcnt(7)
    v_mfma_f32_16x16x32_bf16 v[36:39], v[180:183], v[12:15], v[36:39]
    ds_read_b128 v[180:183], v225 offset:12288
    s_waitcnt lgkmcnt(7)
    v_mfma_f32_16x16x32_bf16 v[36:39], v[184:187], v[24:27], v[36:39]
    ds_read_b128 v[184:187], v226 offset:12288
    s_waitcnt lgkmcnt(7)
    v_mfma_f32_16x16x32_bf16 v[36:39], v[188:191], v[28:31], v[36:39]
    ds_read_b128 v[188:191], v227 offset:12288
    s_waitcnt lgkmcnt(7)
    v_mfma_f32_16x16x32_bf16 v[40:43], v[160:163], v[8:11], 0
    ds_read_b128 v[160:163], v224 offset:16384
    s_waitcnt lgkmcnt(7)
    v_mfma_f32_16x16x32_bf16 v[40:43], v[164:167], v[12:15], v[40:43]
    ds_read_b128 v[164:167], v225 offset:16384
    s_waitcnt lgkmcnt(7)
    v_mfma_f32_16x16x32_bf16 v[40:43], v[168:171], v[24:27], v[40:43]
    ds_read_b128 v[168:171], v226 offset:16384
    s_waitcnt lgkmcnt(7)
    v_mfma_f32_16x16x32_bf16 v[40:43], v[172:175], v[28:31], v[40:43]
    ds_read_b128 v[172:175], v227 offset:16384
    v_max3_f32 v248, v248, v32, v33
    v_max3_f32 v248, v248, v34, v35
    s_waitcnt lgkmcnt(7)
    v_mfma_f32_16x16x32_bf16 v[44:47], v[176:179], v[8:11], 0
    ds_read_b128 v[176:179], v224 offset:20480
    s_waitcnt lgkmcnt(7)
    v_mfma_f32_16x16x32_bf16 v[44:47], v[180:183], v[12:15], v[44:47]
    ds_read_b128 v[180:183], v225 offset:20480
    s_waitcnt lgkmcnt(7)
    v_mfma_f32_16x16x32_bf16 v[44:47], v[184:187], v[24:27], v[44:47]
    ds_read_b128 v[184:187], v226 offset:20480
    s_waitcnt lgkmcnt(7)
    v_mfma_f32_16x16x32_bf16 v[44:47], v[188:191], v[28:31], v[44:47]
    ds_read_b128 v[188:191], v227 offset:20480
    v_max3_f32 v248, v248, v36, v37
    v_max3_f32 v248, v248, v38, v39
    s_waitcnt lgkmcnt(7)
    v_mfma_f32_16x16x32_bf16 v[48:51], v[160:163], v[8:11], 0
    ds_read_b128 v[160:163], v224 offset:24576
    s_waitcnt lgkmcnt(7)
    v_mfma_f32_16x16x32_bf16 v[48:51], v[164:167], v[12:15], v[48:51]
    ds_read_b128 v[164:167], v225 offset:24576
    s_waitcnt lgkmcnt(7)
    v_mfma_f32_16x16x32_bf16 v[48:51], v[168:171], v[24:27], v[48:51]
    ds_read_b128 v[168:171], v226 offset:24576
    s_waitcnt lgkmcnt(7)
    v_mfma_f32_16x16x32_bf16 v[48:51], v[172:175], v[28:31], v[48:51]
    ds_read_b128 v[172:175], v227 offset:24576
    v_max3_f32 v248, v248, v40, v41
    v_max3_f32 v248, v248, v42, v43
    s_waitcnt lgkmcnt(7)
    v_mfma_f32_16x16x32_bf16 v[52:55], v[176:179], v[8:11], 0
    ds_read_b128 v[176:179], v224 offset:28672
    s_waitcnt lgkmcnt(7)
    v_mfma_f32_16x16x32_bf16 v[52:55], v[180:183], v[12:15], v[52:55]
    ds_read_b128 v[180:183], v225 offset:28672
    s_waitcnt lgkmcnt(7)
    v_mfma_f32_16x16x32_bf16 v[52:55], v[184:187], v[24:27], v[52:55]
    ds_read_b128 v[184:187], v226 offset:28672
    s_waitcnt lgkmcnt(7)
    v_mfma_f32_16x16x32_bf16 v[52:55], v[188:191], v[28:31], v[52:55]
    ds_read_b128 v[188:191], v227 offset:28672
    v_max3_f32 v248, v248, v44, v45
    v_max3_f32 v248, v248, v46, v47
    s_waitcnt lgkmcnt(7)
    v_mfma_f32_16x16x32_bf16 v[56:59], v[160:163], v[8:11], 0
    ds_read_b128 v[160:163], v224 offset:32768
    s_waitcnt lgkmcnt(7)
    v_mfma_f32_16x16x32_bf16 v[56:59], v[164:167], v[12:15], v[56:59]
    ds_read_b128 v[164:167], v225 offset:32768
    s_waitcnt lgkmcnt(7)
    v_mfma_f32_16x16x32_bf16 v[56:59], v[168:171], v[24:27], v[56:59]
    ds_read_b128 v[168:171], v226 offset:32768
    s_waitcnt lgkmcnt(7)
    v_mfma_f32_16x16x32_bf16 v[56:59], v[172:175], v[28:31], v[56:59]
    ds_read_b128 v[172:175], v227 offset:32768
    v_max3_f32 v248, v248, v48, v49
    v_max3_f32 v248, v248, v50, v51
    s_waitcnt lgkmcnt(7)
    v_mfma_f32_16x16x32_bf16 v[60:63], v[176:179], v[8:11], 0
    ds_read_b128 v[176:179], v224 offset:36864
    s_waitcnt lgkmcnt(7)
    v_mfma_f32_16x16x32_bf16 v[60:63], v[180:183], v[12:15], v[60:63]
    ds_read_b128 v[180:183], v225 offset:36864
    s_waitcnt lgkmcnt(7)
    v_mfma_f32_16x16x32_bf16 v[60:63], v[184:187], v[24:27], v[60:63]
    ds_read_b128 v[184:187], v226 offset:36864
    s_waitcnt lgkmcnt(7)
    v_mfma_f32_16x16x32_bf16 v[60:63], v[188:191], v[28:31], v[60:63]
    ds_read_b128 v[188:191], v227 offset:36864
    v_max3_f32 v248, v248, v52, v53
    v_max3_f32 v248, v248, v54, v55
    s_waitcnt lgkmcnt(7)
    v_mfma_f32_16x16x32_bf16 v[64:67], v[160:163], v[8:11], 0
    ds_read_b128 v[160:163], v224 offset:40960
    s_waitcnt lgkmcnt(7)
    v_mfma_f32_16x16x32_bf16 v[64:67], v[164:167], v[12:15], v[64:67]
    ds_read_b128 v[164:167], v225 offset:40960
    s_waitcnt lgkmcnt(7)
    v_mfma_f32_16x16x32_bf16 v[64:67], v[168:171], v[24:27], v[64:67]
    ds_read_b128 v[168:171], v226 offset:40960
    s_waitcnt lgkmcnt(7)
    v_mfma_f32_16x16x32_bf16 v[64:67], v[172:175], v[28:31], v[64:67]
    ds_read_b128 v[172:175], v227 offset:40960
    v_max3_f32 v248, v248, v56, v57
    v_max3_f32 v248, v248, v58, v59
    s_waitcnt lgkmcnt(7)
    v_mfma_f32_16x16x32_bf16 v[68:71], v[176:179], v[8:11], 0
    ds_read_b128 v[176:179], v224 offset:45056
    s_waitcnt lgkmcnt(7)
    v_mfma_f32_16x16x32_bf16 v[68:71], v[180:183], v[12:15], v[68:71]
    ds_read_b128 v[180:183], v225 offset:45056
    s_waitcnt lgkmcnt(7)
    v_mfma_f32_16x16x32_bf16 v[68:71], v[184:187], v[24:27], v[68:71]
    ds_read_b128 v[184:187], v226 offset:45056
    s_waitcnt lgkmcnt(7)
    v_mfma_f32_16x16x32_bf16 v[68:71], v[188:191], v[28:31], v[68:71]
    ds_read_b128 v[188:191], v227 offset:45056
    v_max3_f32 v248, v248, v60, v61
    v_max3_f32 v248, v248, v62, v63
    s_waitcnt lgkmcnt(7)
    v_mfma_f32_16x16x32_bf16 v[72:75], v[160:163], v[8:11], 0
    ds_read_b128 v[160:163], v224 offset:49152
    s_waitcnt lgkmcnt(7)
    v_mfma_f32_16x16x32_bf16 v[72:75], v[164:167], v[12:15], v[72:75]
    ds_read_b128 v[164:167], v225 offset:49152
    s_waitcnt lgkmcnt(7)
    v_mfma_f32_16x16x32_bf16 v[72:75], v[168:171], v[24:27], v[72:75]
    ds_read_b128 v[168:171], v226 offset:49152
    s_waitcnt lgkmcnt(7)
    v_mfma_f32_16x16x32_bf16 v[72:75], v[172:175], v[28:31], v[72:75]
    ds_read_b128 v[172:175], v227 offset:49152
    v_max3_f32 v248, v248, v64, v65
    v_max3_f32 v248, v248, v66, v67
    s_waitcnt lgkmcnt(7)
    v_mfma_f32_16x16x32_bf16 v[76:79], v[176:179], v[8:11], 0
    ds_read_b128 v[176:179], v224 offset:53248
    s_waitcnt lgkmcnt(7)
    v_mfma_f32_16x16x32_bf16 v[76:79], v[180:183], v[12:15], v[76:79]
    ds_read_b128 v[180:183], v225 offset:53248
    s_waitcnt lgkmcnt(7)
    v_mfma_f32_16x16x32_bf16 v[76:79], v[184:187], v[24:27], v[76:79]
    ds_read_b128 v[184:187], v226 offset:53248
    s_waitcnt lgkmcnt(7)
    v_mfma_f32_16x16x32_bf16 v[76:79], v[188:191], v[28:31], v[76:79]
    ds_read_b128 v[188:191], v227 offset:53248
    v_max3_f32 v248, v248, v68, v69
    v_max3_f32 v248, v248, v70, v71
    s_waitcnt lgkmcnt(7)
    v_mfma_f32_16x16x32_bf16 v[80:83], v[160:163], v[8:11], 0
    ds_read_b128 v[160:163], v224 offset:57344
    s_waitcnt lgkmcnt(7)
    v_mfma_f32_16x16x32_bf16 v[80:83], v[164:167], v[12:15], v[80:83]
    ds_read_b128 v[164:167], v225 offset:57344
    s_waitcnt lgkmcnt(7)
    v_mfma_f32_16x16x32_bf16 v[80:83], v[168:171], v[24:27], v[80:83]
    ds_read_b128 v[168:171], v226 offset:57344
    s_waitcnt lgkmcnt(7)
    v_mfma_f32_16x16x32_bf16 v[80:83], v[172:175], v[28:31], v[80:83]
    ds_read_b128 v[172:175], v227 offset:57344
    v_max3_f32 v248, v248, v72, v73
    v_max3_f32 v248, v248, v74, v75
    s_waitcnt lgkmcnt(7)
    v_mfma_f32_16x16x32_bf16 v[84:87], v[176:179], v[8:11], 0
    ds_read_b128 v[176:179], v224 offset:61440
    s_waitcnt lgkmcnt(7)
    v_mfma_f32_16x16x32_bf16 v[84:87], v[180:183], v[12:15], v[84:87]
    ds_read_b128 v[180:183], v225 offset:61440
    s_waitcnt lgkmcnt(7)
    v_mfma_f32_16x16x32_bf16 v[84:87], v[184:187], v[24:27], v[84:87]
    ds_read_b128 v[184:187], v226 offset:61440
    s_waitcnt lgkmcnt(7)
    v_mfma_f32_16x16x32_bf16 v[84:87], v[188:191], v[28:31], v[84:87]
    ds_read_b128 v[188:191], v227 offset:61440
    v_max3_f32 v248, v248, v76, v77
    v_max3_f32 v248, v248, v78, v79
    s_waitcnt lgkmcnt(7)
    v_mfma_f32_16x16x32_bf16 v[88:91], v[160:163], v[8:11], 0
    v_add_u32 v224, 0x10000, v224
    v_add_u32 v225, 0x10000, v225
    v_add_u32 v226, 0x10000, v226
    v_add_u32 v227, 0x10000, v227
    ds_read_b128 v[160:163], v224 offset:0
    s_waitcnt lgkmcnt(7)
    v_mfma_f32_16x16x32_bf16 v[88:91], v[164:167], v[12:15], v[88:91]
    ds_read_b128 v[164:167], v225 offset:0
    s_waitcnt lgkmcnt(7)
    v_mfma_f32_16x16x32_bf16 v[88:91], v[168:171], v[24:27], v[88:91]
    ds_read_b128 v[168:171], v226 offset:0
    s_waitcnt lgkmcnt(7)
    v_mfma_f32_16x16x32_bf16 v[88:91], v[172:175], v[28:31], v[88:91]
    ds_read_b128 v[172:175], v227 offset:0
    v_max3_f32 v248, v248, v80, v81
    v_max3_f32 v248, v248, v82, v83
    s_waitcnt lgkmcnt(7)
    v_mfma_f32_16x16x32_bf16 v[92:95], v[176:179], v[8:11], 0
    ds_read_b128 v[176:179], v224 offset:4096
    s_waitcnt lgkmcnt(7)
    v_mfma_f32_16x16x32_bf16 v[92:95], v[180:183], v[12:15], v[92:95]
    ds_read_b128 v[180:183], v225 offset:4096
    s_waitcnt lgkmcnt(7)
    v_mfma_f32_16x16x32_bf16 v[92:95], v[184:187], v[24:27], v[92:95]
    ds_read_b128 v[184:187], v226 offset:4096
    s_waitcnt lgkmcnt(7)
    v_mfma_f32_16x16x32_bf16 v[92:95], v[188:191], v[28:31], v[92:95]
    ds_read_b128 v[188:191], v227 offset:4096
    v_max3_f32 v248, v248, v84, v85
    v_max3_f32 v248, v248, v86, v87
    s_waitcnt lgkmcnt(7)
    v_mfma_f32_16x16x32_bf16 v[96:99], v[160:163], v[8:11], 0
    ds_read_b128 v[160:163], v224 offset:8192
    s_waitcnt lgkmcnt(7)
    v_mfma_f32_16x16x32_bf16 v[96:99], v[164:167], v[12:15], v[96:99]
    ds_read_b128 v[164:167], v225 offset:8192
    s_waitcnt lgkmcnt(7)
    v_mfma_f32_16x16x32_bf16 v[96:99], v[168:171], v[24:27], v[96:99]
    ds_read_b128 v[168:171], v226 offset:8192
    s_waitcnt lgkmcnt(7)
    v_mfma_f32_16x16x32_bf16 v[96:99], v[172:175], v[28:31], v[96:99]
    ds_read_b128 v[172:175], v227 offset:8192
    v_max3_f32 v248, v248, v88, v89
    v_max3_f32 v248, v248, v90, v91
    s_waitcnt lgkmcnt(7)
    v_mfma_f32_16x16x32_bf16 v[100:103], v[176:179], v[8:11], 0
    ds_read_b128 v[176:179], v224 offset:12288
    s_waitcnt lgkmcnt(7)
    v_mfma_f32_16x16x32_bf16 v[100:103], v[180:183], v[12:15], v[100:103]
    ds_read_b128 v[180:183], v225 offset:12288
    s_waitcnt lgkmcnt(7)
    v_mfma_f32_16x16x32_bf16 v[100:103], v[184:187], v[24:27], v[100:103]
    ds_read_b128 v[184:187], v226 offset:12288
    s_waitcnt lgkmcnt(7)
    v_mfma_f32_16x16x32_bf16 v[100:103], v[188:191], v[28:31], v[100:103]
    ds_read_b128 v[188:191], v227 offset:12288
    v_max3_f32 v248, v248, v92, v93
    v_max3_f32 v248, v248, v94, v95
    s_waitcnt lgkmcnt(7)
    v_mfma_f32_16x16x32_bf16 v[104:107], v[160:163], v[8:11], 0
    s_waitcnt lgkmcnt(6)
    v_mfma_f32_16x16x32_bf16 v[104:107], v[164:167], v[12:15], v[104:107]
    s_waitcnt lgkmcnt(5)
    v_mfma_f32_16x16x32_bf16 v[104:107], v[168:171], v[24:27], v[104:107]
    s_waitcnt lgkmcnt(4)
    v_mfma_f32_16x16x32_bf16 v[104:107], v[172:175], v[28:31], v[104:107]
    v_max3_f32 v248, v248, v96, v97
    v_max3_f32 v248, v248, v98, v99
    s_waitcnt lgkmcnt(3)
    v_mfma_f32_16x16x32_bf16 v[108:111], v[176:179], v[8:11], 0
    s_waitcnt lgkmcnt(2)
    v_mfma_f32_16x16x32_bf16 v[108:111], v[180:183], v[12:15], v[108:111]
    s_waitcnt lgkmcnt(1)
    v_mfma_f32_16x16x32_bf16 v[108:111], v[184:187], v[24:27], v[108:111]
    s_waitcnt lgkmcnt(0)
    v_mfma_f32_16x16x32_bf16 v[108:111], v[188:191], v[28:31], v[108:111]
    v_max3_f32 v248, v248, v100, v101
    v_max3_f32 v248, v248, v102, v103
    v_max3_f32 v248, v248, v104, v105
    v_max3_f32 v248, v248, v106, v107
    s_nop 3
    v_max3_f32 v248, v248, v108, v109
    v_max3_f32 v248, v248, v110, v111
    v_mov_b32 v252, v248
    s_nop 0
    s_nop 0
    v_permlane16_swap_b32 v248, v252
    v_max_f32 v248, v248, v252
    v_mov_b32 v252, v248
    s_nop 0
    s_nop 0
    v_permlane32_swap_b32 v248, v252
    v_max_f32 v248, v248, v252
    v_mul_f32 v248, 0xbe0293ee, v248
    v_mov_b32 v144, 0x3f803f80
    v_mov_b32 v145, 0x3f803f80
    v_mov_b32 v146, 0x3f803f80
    v_mov_b32 v147, 0x3f803f80
    v_and_b32 v152, 1, v251
    v_mul_u32_u24 v152, 0xaaaa, v152
    v_add_u32 v152, 0x4444, v152
    v_mov_b32 v148, 0
    v_mov_b32 v149, 0
    v_mov_b32 v150, 0
    v_mov_b32 v151, 0
    v_fmamk_f32 v32, v32, 0x3e0293ee, v248
    v_fmamk_f32 v33, v33, 0x3e0293ee, v248
    v_fmamk_f32 v34, v34, 0x3e0293ee, v248
    v_fmamk_f32 v35, v35, 0x3e0293ee, v248
    v_exp_f32 v32, v32
    v_fmamk_f32 v36, v36, 0x3e0293ee, v248
    v_exp_f32 v33, v33
    v_fmamk_f32 v37, v37, 0x3e0293ee, v248
    v_exp_f32 v34, v34
    v_fmamk_f32 v38, v38, 0x3e0293ee, v248
    v_exp_f32 v35, v35
    v_fmamk_f32 v39, v39, 0x3e0293ee, v248
    v_exp_f32 v36, v36
    v_cvt_pk_bf16_f32 v32, v32, v33
    v_exp_f32 v37, v37
    v_exp_f32 v38, v38
    v_cvt_pk_bf16_f32 v33, v34, v35
    v_exp_f32 v39, v39
    v_cvt_pk_bf16_f32 v34, v36, v37
    v_cvt_pk_bf16_f32 v35, v38, v39
    v_fmamk_f32 v40, v40, 0x3e0293ee, v248
    v_fmamk_f32 v41, v41, 0x3e0293ee, v248
    v_fmamk_f32 v42, v42, 0x3e0293ee, v248
    v_fmamk_f32 v43, v43, 0x3e0293ee, v248
    v_exp_f32 v40, v40
    v_fmamk_f32 v44, v44, 0x3e0293ee, v248
    v_exp_f32 v41, v41
    v_fmamk_f32 v45, v45, 0x3e0293ee, v248
    v_exp_f32 v42, v42
    v_fmamk_f32 v46, v46, 0x3e0293ee, v248
    v_exp_f32 v43, v43
    v_fmamk_f32 v47, v47, 0x3e0293ee, v248
    v_exp_f32 v44, v44
    v_cvt_pk_bf16_f32 v36, v40, v41
    v_exp_f32 v45, v45
    v_exp_f32 v46, v46
    v_cvt_pk_bf16_f32 v37, v42, v43
    v_exp_f32 v47, v47
    v_cvt_pk_bf16_f32 v38, v44, v45
    v_cvt_pk_bf16_f32 v39, v46, v47
    v_fmamk_f32 v48, v48, 0x3e0293ee, v248
    v_fmamk_f32 v49, v49, 0x3e0293ee, v248
    v_fmamk_f32 v50, v50, 0x3e0293ee, v248
    v_fmamk_f32 v51, v51, 0x3e0293ee, v248
    v_exp_f32 v48, v48
    v_fmamk_f32 v52, v52, 0x3e0293ee, v248
    v_exp_f32 v49, v49
    v_fmamk_f32 v53, v53, 0x3e0293ee, v248
    v_exp_f32 v50, v50
    v_fmamk_f32 v54, v54, 0x3e0293ee, v248
    v_exp_f32 v51, v51
    v_fmamk_f32 v55, v55, 0x3e0293ee, v248
    v_exp_f32 v52, v52
    v_cvt_pk_bf16_f32 v48, v48, v49
    v_exp_f32 v53, v53
    v_exp_f32 v54, v54
    v_cvt_pk_bf16_f32 v49, v50, v51
    v_exp_f32 v55, v55
    v_cvt_pk_bf16_f32 v50, v52, v53
    v_cvt_pk_bf16_f32 v51, v54, v55
    v_fmamk_f32 v56, v56, 0x3e0293ee, v248
    v_fmamk_f32 v57, v57, 0x3e0293ee, v248
    v_fmamk_f32 v58, v58, 0x3e0293ee, v248
    v_fmamk_f32 v59, v59, 0x3e0293ee, v248
    v_exp_f32 v56, v56
    v_fmamk_f32 v60, v60, 0x3e0293ee, v248
    v_exp_f32 v57, v57
    v_fmamk_f32 v61, v61, 0x3e0293ee, v248
    v_exp_f32 v58, v58
    v_fmamk_f32 v62, v62, 0x3e0293ee, v248
    v_exp_f32 v59, v59
    v_fmamk_f32 v63, v63, 0x3e0293ee, v248
    v_exp_f32 v60, v60
    v_cvt_pk_bf16_f32 v52, v56, v57
    v_exp_f32 v61, v61
    v_exp_f32 v62, v62
    v_cvt_pk_bf16_f32 v53, v58, v59
    v_exp_f32 v63, v63
    v_cvt_pk_bf16_f32 v54, v60, v61
    v_cvt_pk_bf16_f32 v55, v62, v63
    v_fmamk_f32 v64, v64, 0x3e0293ee, v248
    v_fmamk_f32 v65, v65, 0x3e0293ee, v248
    v_fmamk_f32 v66, v66, 0x3e0293ee, v248
    v_fmamk_f32 v67, v67, 0x3e0293ee, v248
    v_exp_f32 v64, v64
    v_fmamk_f32 v68, v68, 0x3e0293ee, v248
    v_exp_f32 v65, v65
    v_fmamk_f32 v69, v69, 0x3e0293ee, v248
    v_exp_f32 v66, v66
    v_fmamk_f32 v70, v70, 0x3e0293ee, v248
    v_exp_f32 v67, v67
    v_fmamk_f32 v71, v71, 0x3e0293ee, v248
    v_exp_f32 v68, v68
    v_cvt_pk_bf16_f32 v64, v64, v65
    v_exp_f32 v69, v69
    v_exp_f32 v70, v70
    v_cvt_pk_bf16_f32 v65, v66, v67
    v_exp_f32 v71, v71
    v_cvt_pk_bf16_f32 v66, v68, v69
    v_cvt_pk_bf16_f32 v67, v70, v71
    v_fmamk_f32 v72, v72, 0x3e0293ee, v248
    v_fmamk_f32 v73, v73, 0x3e0293ee, v248
    v_fmamk_f32 v74, v74, 0x3e0293ee, v248
    v_fmamk_f32 v75, v75, 0x3e0293ee, v248
    v_exp_f32 v72, v72
    v_fmamk_f32 v76, v76, 0x3e0293ee, v248
    v_exp_f32 v73, v73
    v_fmamk_f32 v77, v77, 0x3e0293ee, v248
    v_exp_f32 v74, v74
    v_fmamk_f32 v78, v78, 0x3e0293ee, v248
    v_exp_f32 v75, v75
    v_fmamk_f32 v79, v79, 0x3e0293ee, v248
    v_exp_f32 v76, v76
    v_cvt_pk_bf16_f32 v68, v72, v73
    v_exp_f32 v77, v77
    v_exp_f32 v78, v78
    v_cvt_pk_bf16_f32 v69, v74, v75
    v_exp_f32 v79, v79
    v_cvt_pk_bf16_f32 v70, v76, v77
    v_cvt_pk_bf16_f32 v71, v78, v79
    v_fmamk_f32 v80, v80, 0x3e0293ee, v248
    v_fmamk_f32 v81, v81, 0x3e0293ee, v248
    v_fmamk_f32 v82, v82, 0x3e0293ee, v248
    v_fmamk_f32 v83, v83, 0x3e0293ee, v248
    v_exp_f32 v80, v80
    v_fmamk_f32 v84, v84, 0x3e0293ee, v248
    v_exp_f32 v81, v81
    v_fmamk_f32 v85, v85, 0x3e0293ee, v248
    v_exp_f32 v82, v82
    v_fmamk_f32 v86, v86, 0x3e0293ee, v248
    v_exp_f32 v83, v83
    v_fmamk_f32 v87, v87, 0x3e0293ee, v248
    v_exp_f32 v84, v84
    v_cvt_pk_bf16_f32 v80, v80, v81
    v_exp_f32 v85, v85
    v_exp_f32 v86, v86
    v_cvt_pk_bf16_f32 v81, v82, v83
    v_exp_f32 v87, v87
    v_cvt_pk_bf16_f32 v82, v84, v85
    v_cvt_pk_bf16_f32 v83, v86, v87
    v_fmamk_f32 v88, v88, 0x3e0293ee, v248
    v_fmamk_f32 v89, v89, 0x3e0293ee, v248
    v_fmamk_f32 v90, v90, 0x3e0293ee, v248
    v_fmamk_f32 v91, v91, 0x3e0293ee, v248
    v_exp_f32 v88, v88
    v_fmamk_f32 v92, v92, 0x3e0293ee, v248
    v_exp_f32 v89, v89
    v_fmamk_f32 v93, v93, 0x3e0293ee, v248
    v_exp_f32 v90, v90
    v_fmamk_f32 v94, v94, 0x3e0293ee, v248
    v_exp_f32 v91, v91
    v_fmamk_f32 v95, v95, 0x3e0293ee, v248
    v_exp_f32 v92, v92
    v_cvt_pk_bf16_f32 v84, v88, v89
    v_exp_f32 v93, v93
    v_exp_f32 v94, v94
    v_cvt_pk_bf16_f32 v85, v90, v91
    v_exp_f32 v95, v95
    v_cvt_pk_bf16_f32 v86, v92, v93
    v_cvt_pk_bf16_f32 v87, v94, v95
    v_fmamk_f32 v96, v96, 0x3e0293ee, v248
    v_fmamk_f32 v97, v97, 0x3e0293ee, v248
    v_fmamk_f32 v98, v98, 0x3e0293ee, v248
    v_fmamk_f32 v99, v99, 0x3e0293ee, v248
    v_exp_f32 v96, v96
    v_fmamk_f32 v100, v100, 0x3e0293ee, v248
    v_exp_f32 v97, v97
    v_fmamk_f32 v101, v101, 0x3e0293ee, v248
    v_exp_f32 v98, v98
    v_fmamk_f32 v102, v102, 0x3e0293ee, v248
    v_exp_f32 v99, v99
    v_fmamk_f32 v103, v103, 0x3e0293ee, v248
    v_exp_f32 v100, v100
    v_cvt_pk_bf16_f32 v96, v96, v97
    v_exp_f32 v101, v101
    v_exp_f32 v102, v102
    v_cvt_pk_bf16_f32 v97, v98, v99
    v_exp_f32 v103, v103
    v_cvt_pk_bf16_f32 v98, v100, v101
    v_cvt_pk_bf16_f32 v99, v102, v103
    ds_read_b64_tr_b16 v[160:161], v228 offset:0
    ds_read_b64_tr_b16 v[162:163], v228 offset:4096
    ds_read_b64_tr_b16 v[164:165], v229 offset:0
    ds_read_b64_tr_b16 v[166:167], v229 offset:4096
    ds_read_b64_tr_b16 v[168:169], v228 offset:8192
    ds_read_b64_tr_b16 v[170:171], v228 offset:12288
    ds_read_b64_tr_b16 v[172:173], v229 offset:8192
    ds_read_b64_tr_b16 v[174:175], v229 offset:12288
    ds_read_b64_tr_b16 v[176:177], v228 offset:16384
    ds_read_b64_tr_b16 v[178:179], v228 offset:20480
    ds_read_b64_tr_b16 v[180:181], v229 offset:16384
    ds_read_b64_tr_b16 v[182:183], v229 offset:20480
    ds_read_b64_tr_b16 v[184:185], v228 offset:24576
    ds_read_b64_tr_b16 v[186:187], v228 offset:28672
    v_fmamk_f32 v104, v104, 0x3e0293ee, v248
    v_fmamk_f32 v105, v105, 0x3e0293ee, v248
    v_fmamk_f32 v106, v106, 0x3e0293ee, v248
    v_fmamk_f32 v107, v107, 0x3e0293ee, v248
    v_exp_f32 v104, v104
    v_fmamk_f32 v108, v108, 0x3e0293ee, v248
    v_exp_f32 v105, v105
    v_fmamk_f32 v109, v109, 0x3e0293ee, v248
    v_exp_f32 v106, v106
    v_fmamk_f32 v110, v110, 0x3e0293ee, v248
    v_exp_f32 v107, v107
    v_fmamk_f32 v111, v111, 0x3e0293ee, v248
    v_exp_f32 v108, v108
    v_cvt_pk_bf16_f32 v100, v104, v105
    v_exp_f32 v109, v109
    v_exp_f32 v110, v110
    v_cvt_pk_bf16_f32 v101, v106, v107
    v_exp_f32 v111, v111
    v_cvt_pk_bf16_f32 v102, v108, v109
    v_cvt_pk_bf16_f32 v103, v110, v111
    s_waitcnt lgkmcnt(12)
    v_mfma_f32_16x16x32_bf16 v[112:115], v[160:163], v[32:35], 0
    ds_read_b64_tr_b16 v[188:189], v229 offset:24576
    ds_read_b64_tr_b16 v[190:191], v229 offset:28672
    s_waitcnt lgkmcnt(12)
    v_mfma_f32_16x16x32_bf16 v[116:119], v[164:167], v[32:35], 0
    ds_read_b64_tr_b16 v[160:161], v228 offset:32768
    ds_read_b64_tr_b16 v[162:163], v228 offset:36864
    s_waitcnt lgkmcnt(12)
    v_mfma_f32_16x16x32_bf16 v[112:115], v[168:171], v[36:39], v[112:115]
    ds_read_b64_tr_b16 v[164:165], v229 offset:32768
    ds_read_b64_tr_b16 v[166:167], v229 offset:36864
    s_waitcnt lgkmcnt(12)
    v_mfma_f32_16x16x32_bf16 v[116:119], v[172:175], v[36:39], v[116:119]
    ds_read_b64_tr_b16 v[168:169], v228 offset:40960
    ds_read_b64_tr_b16 v[170:171], v228 offset:45056
    v_smfmac_f32_16x16x64_bf16 v[148:151], v[144:147], v[32:39], v152
    s_waitcnt lgkmcnt(12)
    v_mfma_f32_16x16x32_bf16 v[112:115], v[176:179], v[48:51], v[112:115]
    ds_read_b64_tr_b16 v[172:173], v229 offset:40960
    ds_read_b64_tr_b16 v[174:175], v229 offset:45056
    s_waitcnt lgkmcnt(12)
    v_mfma_f32_16x16x32_bf16 v[116:119], v[180:183], v[48:51], v[116:119]
    ds_read_b64_tr_b16 v[176:177], v228 offset:49152
    ds_read_b64_tr_b16 v[178:179], v228 offset:53248
    s_waitcnt lgkmcnt(12)
    v_mfma_f32_16x16x32_bf16 v[112:115], v[184:187], v[52:55], v[112:115]
    ds_read_b64_tr_b16 v[180:181], v229 offset:49152
    ds_read_b64_tr_b16 v[182:183], v229 offset:53248
    s_waitcnt lgkmcnt(12)
    v_mfma_f32_16x16x32_bf16 v[116:119], v[188:191], v[52:55], v[116:119]
    ds_read_b64_tr_b16 v[184:185], v228 offset:57344
    ds_read_b64_tr_b16 v[186:187], v228 offset:61440
    v_smfmac_f32_16x16x64_bf16 v[148:151], v[144:147], v[48:55], v152
    s_waitcnt lgkmcnt(12)
    v_mfma_f32_16x16x32_bf16 v[112:115], v[160:163], v[64:67], v[112:115]
    ds_read_b64_tr_b16 v[188:189], v229 offset:57344
    ds_read_b64_tr_b16 v[190:191], v229 offset:61440
    s_waitcnt lgkmcnt(12)
    v_mfma_f32_16x16x32_bf16 v[116:119], v[164:167], v[64:67], v[116:119]
    v_add_u32 v228, 0x10000, v228
    ds_read_b64_tr_b16 v[160:161], v228 offset:0
    ds_read_b64_tr_b16 v[162:163], v228 offset:4096
    s_waitcnt lgkmcnt(12)
    v_mfma_f32_16x16x32_bf16 v[112:115], v[168:171], v[68:71], v[112:115]
    v_add_u32 v229, 0x10000, v229
    ds_read_b64_tr_b16 v[164:165], v229 offset:0
    ds_read_b64_tr_b16 v[166:167], v229 offset:4096
    s_waitcnt lgkmcnt(12)
    v_mfma_f32_16x16x32_bf16 v[116:119], v[172:175], v[68:71], v[116:119]
    ds_read_b64_tr_b16 v[168:169], v228 offset:8192
    ds_read_b64_tr_b16 v[170:171], v228 offset:12288
    v_smfmac_f32_16x16x64_bf16 v[148:151], v[144:147], v[64:71], v152
    s_waitcnt lgkmcnt(12)
    v_mfma_f32_16x16x32_bf16 v[112:115], v[176:179], v[80:83], v[112:115]
    ds_read_b64_tr_b16 v[172:173], v229 offset:8192
    ds_read_b64_tr_b16 v[174:175], v229 offset:12288
    s_waitcnt lgkmcnt(12)
    v_mfma_f32_16x16x32_bf16 v[116:119], v[180:183], v[80:83], v[116:119]
    ds_read_b64_tr_b16 v[176:177], v230 offset:0
    ds_read_b64_tr_b16 v[178:179], v230 offset:4096
    s_waitcnt lgkmcnt(12)
    v_mfma_f32_16x16x32_bf16 v[112:115], v[184:187], v[84:87], v[112:115]
    ds_read_b64_tr_b16 v[180:181], v231 offset:0
    ds_read_b64_tr_b16 v[182:183], v231 offset:4096
    s_waitcnt lgkmcnt(12)
    v_mfma_f32_16x16x32_bf16 v[116:119], v[188:191], v[84:87], v[116:119]
    ds_read_b64_tr_b16 v[184:185], v230 offset:8192
    ds_read_b64_tr_b16 v[186:187], v230 offset:12288
    v_smfmac_f32_16x16x64_bf16 v[148:151], v[144:147], v[80:87], v152
    s_waitcnt lgkmcnt(12)
    v_mfma_f32_16x16x32_bf16 v[112:115], v[160:163], v[96:99], v[112:115]
    ds_read_b64_tr_b16 v[188:189], v231 offset:8192
    ds_read_b64_tr_b16 v[190:191], v231 offset:12288
    s_waitcnt lgkmcnt(12)
    v_mfma_f32_16x16x32_bf16 v[116:119], v[164:167], v[96:99], v[116:119]
    ds_read_b64_tr_b16 v[160:161], v230 offset:16384
    ds_read_b64_tr_b16 v[162:163], v230 offset:20480
    s_waitcnt lgkmcnt(12)
    v_mfma_f32_16x16x32_bf16 v[112:115], v[168:171], v[100:103], v[112:115]
    ds_read_b64_tr_b16 v[164:165], v231 offset:16384
    ds_read_b64_tr_b16 v[166:167], v231 offset:20480
    s_waitcnt lgkmcnt(12)
    v_mfma_f32_16x16x32_bf16 v[116:119], v[172:175], v[100:103], v[116:119]
    ds_read_b64_tr_b16 v[168:169], v230 offset:24576
    ds_read_b64_tr_b16 v[170:171], v230 offset:28672
    v_smfmac_f32_16x16x64_bf16 v[148:151], v[144:147], v[96:103], v152
    s_waitcnt lgkmcnt(12)
    v_mfma_f32_16x16x32_bf16 v[120:123], v[176:179], v[32:35], 0
    ds_read_b64_tr_b16 v[172:173], v231 offset:24576
    ds_read_b64_tr_b16 v[174:175], v231 offset:28672
    s_waitcnt lgkmcnt(12)
    v_mfma_f32_16x16x32_bf16 v[124:127], v[180:183], v[32:35], 0
    ds_read_b64_tr_b16 v[176:177], v230 offset:32768
    ds_read_b64_tr_b16 v[178:179], v230 offset:36864
    s_waitcnt lgkmcnt(12)
    v_mfma_f32_16x16x32_bf16 v[120:123], v[184:187], v[36:39], v[120:123]
    ds_read_b64_tr_b16 v[180:181], v231 offset:32768
    ds_read_b64_tr_b16 v[182:183], v231 offset:36864
    s_waitcnt lgkmcnt(12)
    v_mfma_f32_16x16x32_bf16 v[124:127], v[188:191], v[36:39], v[124:127]
    ds_read_b64_tr_b16 v[184:185], v230 offset:40960
    ds_read_b64_tr_b16 v[186:187], v230 offset:45056
    v_add_f32 v148, v148, v149
    v_rcp_f32 v249, v148
    s_waitcnt lgkmcnt(12)
    v_mfma_f32_16x16x32_bf16 v[120:123], v[160:163], v[48:51], v[120:123]
    ds_read_b64_tr_b16 v[188:189], v231 offset:40960
    ds_read_b64_tr_b16 v[190:191], v231 offset:45056
    v_mul_f32 v112, v112, v249
    v_mul_f32 v113, v113, v249
    s_waitcnt lgkmcnt(12)
    v_mfma_f32_16x16x32_bf16 v[124:127], v[164:167], v[48:51], v[124:127]
    ds_read_b64_tr_b16 v[160:161], v230 offset:49152
    ds_read_b64_tr_b16 v[162:163], v230 offset:53248
    v_mul_f32 v114, v114, v249
    v_mul_f32 v115, v115, v249
    s_waitcnt lgkmcnt(12)
    v_mfma_f32_16x16x32_bf16 v[120:123], v[168:171], v[52:55], v[120:123]
    ds_read_b64_tr_b16 v[164:165], v231 offset:49152
    ds_read_b64_tr_b16 v[166:167], v231 offset:53248
    v_mul_f32 v116, v116, v249
    v_mul_f32 v117, v117, v249
    s_waitcnt lgkmcnt(12)
    v_mfma_f32_16x16x32_bf16 v[124:127], v[172:175], v[52:55], v[124:127]
    ds_read_b64_tr_b16 v[168:169], v230 offset:57344
    ds_read_b64_tr_b16 v[170:171], v230 offset:61440
    v_mul_f32 v118, v118, v249
    v_mul_f32 v119, v119, v249
    s_waitcnt lgkmcnt(12)
    v_mfma_f32_16x16x32_bf16 v[120:123], v[176:179], v[64:67], v[120:123]
    ds_read_b64_tr_b16 v[172:173], v231 offset:57344
    ds_read_b64_tr_b16 v[174:175], v231 offset:61440
    v_cvt_pk_bf16_f32 v112, v112, v113
    v_cvt_pk_bf16_f32 v113, v114, v115
    s_waitcnt lgkmcnt(12)
    v_mfma_f32_16x16x32_bf16 v[124:127], v[180:183], v[64:67], v[124:127]
    v_add_u32 v230, 0x10000, v230
    ds_read_b64_tr_b16 v[176:177], v230 offset:0
    ds_read_b64_tr_b16 v[178:179], v230 offset:4096
    v_cvt_pk_bf16_f32 v114, v116, v117
    v_cvt_pk_bf16_f32 v115, v118, v119
    s_waitcnt lgkmcnt(12)
    v_mfma_f32_16x16x32_bf16 v[120:123], v[184:187], v[68:71], v[120:123]
    v_add_u32 v231, 0x10000, v231
    ds_read_b64_tr_b16 v[180:181], v231 offset:0
    ds_read_b64_tr_b16 v[182:183], v231 offset:4096
    v_permlane16_swap_b32 v112, v114
    v_permlane16_swap_b32 v113, v115
    s_waitcnt lgkmcnt(12)
    v_mfma_f32_16x16x32_bf16 v[124:127], v[188:191], v[68:71], v[124:127]
    ds_read_b64_tr_b16 v[184:185], v230 offset:8192
    ds_read_b64_tr_b16 v[186:187], v230 offset:12288
    buffer_store_dwordx4 v[112:115], v250, s[32:35], s51 offen offset:0 sc1
    s_waitcnt lgkmcnt(12)
    v_mfma_f32_16x16x32_bf16 v[120:123], v[160:163], v[80:83], v[120:123]
    ds_read_b64_tr_b16 v[188:189], v231 offset:8192
    ds_read_b64_tr_b16 v[190:191], v231 offset:12288
    s_waitcnt lgkmcnt(12)
    v_mfma_f32_16x16x32_bf16 v[124:127], v[164:167], v[80:83], v[124:127]
    ds_read_b64_tr_b16 v[160:161], v232 offset:0
    ds_read_b64_tr_b16 v[162:163], v232 offset:4096
    s_waitcnt lgkmcnt(12)
    v_mfma_f32_16x16x32_bf16 v[120:123], v[168:171], v[84:87], v[120:123]
    ds_read_b64_tr_b16 v[164:165], v233 offset:0
    ds_read_b64_tr_b16 v[166:167], v233 offset:4096
    s_waitcnt lgkmcnt(12)
    v_mfma_f32_16x16x32_bf16 v[124:127], v[172:175], v[84:87], v[124:127]
    ds_read_b64_tr_b16 v[168:169], v232 offset:8192
    ds_read_b64_tr_b16 v[170:171], v232 offset:12288
    s_waitcnt lgkmcnt(12)
    v_mfma_f32_16x16x32_bf16 v[120:123], v[176:179], v[96:99], v[120:123]
    ds_read_b64_tr_b16 v[172:173], v233 offset:8192
    ds_read_b64_tr_b16 v[174:175], v233 offset:12288
    s_waitcnt lgkmcnt(12)
    v_mfma_f32_16x16x32_bf16 v[124:127], v[180:183], v[96:99], v[124:127]
    ds_read_b64_tr_b16 v[176:177], v232 offset:16384
    ds_read_b64_tr_b16 v[178:179], v232 offset:20480
    s_waitcnt lgkmcnt(12)
    v_mfma_f32_16x16x32_bf16 v[120:123], v[184:187], v[100:103], v[120:123]
    ds_read_b64_tr_b16 v[180:181], v233 offset:16384
    ds_read_b64_tr_b16 v[182:183], v233 offset:20480
    s_waitcnt lgkmcnt(12)
    v_mfma_f32_16x16x32_bf16 v[124:127], v[188:191], v[100:103], v[124:127]
    ds_read_b64_tr_b16 v[184:185], v232 offset:24576
    ds_read_b64_tr_b16 v[186:187], v232 offset:28672
    s_waitcnt lgkmcnt(12)
    v_mfma_f32_16x16x32_bf16 v[128:131], v[160:163], v[32:35], 0
    ds_read_b64_tr_b16 v[188:189], v233 offset:24576
    ds_read_b64_tr_b16 v[190:191], v233 offset:28672
    s_waitcnt lgkmcnt(12)
    v_mfma_f32_16x16x32_bf16 v[132:135], v[164:167], v[32:35], 0
    ds_read_b64_tr_b16 v[160:161], v232 offset:32768
    ds_read_b64_tr_b16 v[162:163], v232 offset:36864
    s_waitcnt lgkmcnt(12)
    v_mfma_f32_16x16x32_bf16 v[128:131], v[168:171], v[36:39], v[128:131]
    ds_read_b64_tr_b16 v[164:165], v233 offset:32768
    ds_read_b64_tr_b16 v[166:167], v233 offset:36864
    s_waitcnt lgkmcnt(12)
    v_mfma_f32_16x16x32_bf16 v[132:135], v[172:175], v[36:39], v[132:135]
    ds_read_b64_tr_b16 v[168:169], v232 offset:40960
    ds_read_b64_tr_b16 v[170:171], v232 offset:45056
    v_mul_f32 v120, v120, v249
    v_mul_f32 v121, v121, v249
    s_waitcnt lgkmcnt(12)
    v_mfma_f32_16x16x32_bf16 v[128:131], v[176:179], v[48:51], v[128:131]
    ds_read_b64_tr_b16 v[172:173], v233 offset:40960
    ds_read_b64_tr_b16 v[174:175], v233 offset:45056
    v_mul_f32 v122, v122, v249
    v_mul_f32 v123, v123, v249
    s_waitcnt lgkmcnt(12)
    v_mfma_f32_16x16x32_bf16 v[132:135], v[180:183], v[48:51], v[132:135]
    ds_read_b64_tr_b16 v[176:177], v232 offset:49152
    ds_read_b64_tr_b16 v[178:179], v232 offset:53248
    v_mul_f32 v124, v124, v249
    v_mul_f32 v125, v125, v249
    s_waitcnt lgkmcnt(12)
    v_mfma_f32_16x16x32_bf16 v[128:131], v[184:187], v[52:55], v[128:131]
    ds_read_b64_tr_b16 v[180:181], v233 offset:49152
    ds_read_b64_tr_b16 v[182:183], v233 offset:53248
    v_mul_f32 v126, v126, v249
    v_mul_f32 v127, v127, v249
    s_waitcnt lgkmcnt(12)
    v_mfma_f32_16x16x32_bf16 v[132:135], v[188:191], v[52:55], v[132:135]
    ds_read_b64_tr_b16 v[184:185], v232 offset:57344
    ds_read_b64_tr_b16 v[186:187], v232 offset:61440
    v_cvt_pk_bf16_f32 v120, v120, v121
    v_cvt_pk_bf16_f32 v121, v122, v123
    s_waitcnt lgkmcnt(12)
    v_mfma_f32_16x16x32_bf16 v[128:131], v[160:163], v[64:67], v[128:131]
    ds_read_b64_tr_b16 v[188:189], v233 offset:57344
    ds_read_b64_tr_b16 v[190:191], v233 offset:61440
    v_cvt_pk_bf16_f32 v122, v124, v125
    v_cvt_pk_bf16_f32 v123, v126, v127
    s_waitcnt lgkmcnt(12)
    v_mfma_f32_16x16x32_bf16 v[132:135], v[164:167], v[64:67], v[132:135]
    v_add_u32 v232, 0x10000, v232
    ds_read_b64_tr_b16 v[160:161], v232 offset:0
    ds_read_b64_tr_b16 v[162:163], v232 offset:4096
    v_permlane16_swap_b32 v120, v122
    v_permlane16_swap_b32 v121, v123
    s_waitcnt lgkmcnt(12)
    v_mfma_f32_16x16x32_bf16 v[128:131], v[168:171], v[68:71], v[128:131]
    v_add_u32 v233, 0x10000, v233
    ds_read_b64_tr_b16 v[164:165], v233 offset:0
    ds_read_b64_tr_b16 v[166:167], v233 offset:4096
    buffer_store_dwordx4 v[120:123], v250, s[32:35], s51 offen offset:64 sc1
    s_waitcnt lgkmcnt(12)
    v_mfma_f32_16x16x32_bf16 v[132:135], v[172:175], v[68:71], v[132:135]
    ds_read_b64_tr_b16 v[168:169], v232 offset:8192
    ds_read_b64_tr_b16 v[170:171], v232 offset:12288
    s_waitcnt lgkmcnt(12)
    v_mfma_f32_16x16x32_bf16 v[128:131], v[176:179], v[80:83], v[128:131]
    ds_read_b64_tr_b16 v[172:173], v233 offset:8192
    ds_read_b64_tr_b16 v[174:175], v233 offset:12288
    s_waitcnt lgkmcnt(12)
    v_mfma_f32_16x16x32_bf16 v[132:135], v[180:183], v[80:83], v[132:135]
    ds_read_b64_tr_b16 v[176:177], v234 offset:0
    ds_read_b64_tr_b16 v[178:179], v234 offset:4096
    s_waitcnt lgkmcnt(12)
    v_mfma_f32_16x16x32_bf16 v[128:131], v[184:187], v[84:87], v[128:131]
    ds_read_b64_tr_b16 v[180:181], v235 offset:0
    ds_read_b64_tr_b16 v[182:183], v235 offset:4096
    s_waitcnt lgkmcnt(12)
    v_mfma_f32_16x16x32_bf16 v[132:135], v[188:191], v[84:87], v[132:135]
    ds_read_b64_tr_b16 v[184:185], v234 offset:8192
    ds_read_b64_tr_b16 v[186:187], v234 offset:12288
    s_waitcnt lgkmcnt(12)
    v_mfma_f32_16x16x32_bf16 v[128:131], v[160:163], v[96:99], v[128:131]
    ds_read_b64_tr_b16 v[188:189], v235 offset:8192
    ds_read_b64_tr_b16 v[190:191], v235 offset:12288
    s_waitcnt lgkmcnt(12)
    v_mfma_f32_16x16x32_bf16 v[132:135], v[164:167], v[96:99], v[132:135]
    ds_read_b64_tr_b16 v[160:161], v234 offset:16384
    ds_read_b64_tr_b16 v[162:163], v234 offset:20480
    s_waitcnt lgkmcnt(12)
    v_mfma_f32_16x16x32_bf16 v[128:131], v[168:171], v[100:103], v[128:131]
    ds_read_b64_tr_b16 v[164:165], v235 offset:16384
    ds_read_b64_tr_b16 v[166:167], v235 offset:20480
    s_waitcnt lgkmcnt(12)
    v_mfma_f32_16x16x32_bf16 v[132:135], v[172:175], v[100:103], v[132:135]
    ds_read_b64_tr_b16 v[168:169], v234 offset:24576
    ds_read_b64_tr_b16 v[170:171], v234 offset:28672
    s_waitcnt lgkmcnt(12)
    v_mfma_f32_16x16x32_bf16 v[136:139], v[176:179], v[32:35], 0
    ds_read_b64_tr_b16 v[172:173], v235 offset:24576
    ds_read_b64_tr_b16 v[174:175], v235 offset:28672
    s_waitcnt lgkmcnt(12)
    v_mfma_f32_16x16x32_bf16 v[140:143], v[180:183], v[32:35], 0
    ds_read_b64_tr_b16 v[176:177], v234 offset:32768
    ds_read_b64_tr_b16 v[178:179], v234 offset:36864
    s_waitcnt lgkmcnt(12)
    v_mfma_f32_16x16x32_bf16 v[136:139], v[184:187], v[36:39], v[136:139]
    ds_read_b64_tr_b16 v[180:181], v235 offset:32768
    ds_read_b64_tr_b16 v[182:183], v235 offset:36864
    s_waitcnt lgkmcnt(12)
    v_mfma_f32_16x16x32_bf16 v[140:143], v[188:191], v[36:39], v[140:143]
    ds_read_b64_tr_b16 v[184:185], v234 offset:40960
    ds_read_b64_tr_b16 v[186:187], v234 offset:45056
    v_mul_f32 v128, v128, v249
    v_mul_f32 v129, v129, v249
    s_waitcnt lgkmcnt(12)
    v_mfma_f32_16x16x32_bf16 v[136:139], v[160:163], v[48:51], v[136:139]
    ds_read_b64_tr_b16 v[188:189], v235 offset:40960
    ds_read_b64_tr_b16 v[190:191], v235 offset:45056
    v_mul_f32 v130, v130, v249
    v_mul_f32 v131, v131, v249
    s_waitcnt lgkmcnt(12)
    v_mfma_f32_16x16x32_bf16 v[140:143], v[164:167], v[48:51], v[140:143]
    ds_read_b64_tr_b16 v[160:161], v234 offset:49152
    ds_read_b64_tr_b16 v[162:163], v234 offset:53248
    v_mul_f32 v132, v132, v249
    v_mul_f32 v133, v133, v249
    s_waitcnt lgkmcnt(12)
    v_mfma_f32_16x16x32_bf16 v[136:139], v[168:171], v[52:55], v[136:139]
    ds_read_b64_tr_b16 v[164:165], v235 offset:49152
    ds_read_b64_tr_b16 v[166:167], v235 offset:53248
    v_mul_f32 v134, v134, v249
    v_mul_f32 v135, v135, v249
    s_waitcnt lgkmcnt(12)
    v_mfma_f32_16x16x32_bf16 v[140:143], v[172:175], v[52:55], v[140:143]
    ds_read_b64_tr_b16 v[168:169], v234 offset:57344
    ds_read_b64_tr_b16 v[170:171], v234 offset:61440
    v_cvt_pk_bf16_f32 v128, v128, v129
    v_cvt_pk_bf16_f32 v129, v130, v131
    s_waitcnt lgkmcnt(12)
    v_mfma_f32_16x16x32_bf16 v[136:139], v[176:179], v[64:67], v[136:139]
    ds_read_b64_tr_b16 v[172:173], v235 offset:57344
    ds_read_b64_tr_b16 v[174:175], v235 offset:61440
    v_cvt_pk_bf16_f32 v130, v132, v133
    v_cvt_pk_bf16_f32 v131, v134, v135
    s_waitcnt lgkmcnt(12)
    v_mfma_f32_16x16x32_bf16 v[140:143], v[180:183], v[64:67], v[140:143]
    v_add_u32 v234, 0x10000, v234
    ds_read_b64_tr_b16 v[176:177], v234 offset:0
    ds_read_b64_tr_b16 v[178:179], v234 offset:4096
    v_permlane16_swap_b32 v128, v130
    v_permlane16_swap_b32 v129, v131
    s_waitcnt lgkmcnt(12)
    v_mfma_f32_16x16x32_bf16 v[136:139], v[184:187], v[68:71], v[136:139]
    v_add_u32 v235, 0x10000, v235
    ds_read_b64_tr_b16 v[180:181], v235 offset:0
    ds_read_b64_tr_b16 v[182:183], v235 offset:4096
    buffer_store_dwordx4 v[128:131], v250, s[32:35], s51 offen offset:128 sc1
    s_waitcnt lgkmcnt(12)
    v_mfma_f32_16x16x32_bf16 v[140:143], v[188:191], v[68:71], v[140:143]
    ds_read_b64_tr_b16 v[184:185], v234 offset:8192
    ds_read_b64_tr_b16 v[186:187], v234 offset:12288
    s_waitcnt lgkmcnt(12)
    v_mfma_f32_16x16x32_bf16 v[136:139], v[160:163], v[80:83], v[136:139]
    ds_read_b64_tr_b16 v[188:189], v235 offset:8192
    ds_read_b64_tr_b16 v[190:191], v235 offset:12288
    s_waitcnt lgkmcnt(12)
    v_mfma_f32_16x16x32_bf16 v[140:143], v[164:167], v[80:83], v[140:143]
    s_waitcnt lgkmcnt(10)
    v_mfma_f32_16x16x32_bf16 v[136:139], v[168:171], v[84:87], v[136:139]
    s_waitcnt lgkmcnt(8)
    v_mfma_f32_16x16x32_bf16 v[140:143], v[172:175], v[84:87], v[140:143]
    s_waitcnt lgkmcnt(6)
    v_mfma_f32_16x16x32_bf16 v[136:139], v[176:179], v[96:99], v[136:139]
    s_waitcnt lgkmcnt(4)
    v_mfma_f32_16x16x32_bf16 v[140:143], v[180:183], v[96:99], v[140:143]
    s_waitcnt lgkmcnt(2)
    v_mfma_f32_16x16x32_bf16 v[136:139], v[184:187], v[100:103], v[136:139]
    s_waitcnt lgkmcnt(0)
    v_mfma_f32_16x16x32_bf16 v[140:143], v[188:191], v[100:103], v[140:143]
    s_nop 5
    v_mul_f32 v136, v136, v249
    v_mul_f32 v137, v137, v249
    v_mul_f32 v138, v138, v249
    v_mul_f32 v139, v139, v249
    v_mul_f32 v140, v140, v249
    v_mul_f32 v141, v141, v249
    v_mul_f32 v142, v142, v249
    v_mul_f32 v143, v143, v249
    v_cvt_pk_bf16_f32 v136, v136, v137
    v_cvt_pk_bf16_f32 v137, v138, v139
    v_cvt_pk_bf16_f32 v138, v140, v141
    v_cvt_pk_bf16_f32 v139, v142, v143
    s_nop 0
    v_permlane16_swap_b32 v136, v138
    v_permlane16_swap_b32 v137, v139
    buffer_store_dwordx4 v[136:139], v250, s[32:35], s51 offen offset:192 sc1
L_fin:
L_end:
    s_endpgm
.section .rodata,"a"
.p2align 6
.amdhsa_kernel standalone__gqa_softmax__near_ridge_kernel
  .amdhsa_next_free_vgpr 256
  .amdhsa_next_free_sgpr 100
  .amdhsa_accum_offset 256
  .amdhsa_group_segment_fixed_size 0
  .amdhsa_kernarg_size 48
  .amdhsa_user_sgpr_count 2
  .amdhsa_user_sgpr_kernarg_segment_ptr 1
  .amdhsa_system_sgpr_workgroup_id_x 1
.end_amdhsa_kernel
```
